```python
import torch

def _softmax(x, axis=-1):
    return torch.softmax(x, dim=axis)
def _gelu(x):
    return torch.nn.functional.gelu(x, approximate="tanh")
def _silu(x):
    return torch.nn.functional.silu(x)
def _sigmoid(x):
    return torch.sigmoid(x)
def _layernorm(x, axis=-1, eps=1e-5):
    m = x.mean(dim=axis, keepdim=True)
    v = x.var(dim=axis, keepdim=True, unbiased=False)
    return (x - m) / torch.sqrt(v + eps)
def _scatter_add(tgt, idx, src, axis=0):
    return tgt.clone().index_add_(axis, idx, src)
def _segment_sum(src, seg, n):
    out = torch.zeros((n,) + src.shape[1:], dtype=src.dtype)
    return out.index_add_(0, seg, src)
def _pad(x, pw):
    flat = tuple(v for pair in reversed(pw) for v in pair)
    return torch.nn.functional.pad(x, flat)

kernel_name = 'parallel_sum__ssm_conv_s4__mixer_channel_mlp__prompt'

def setup_inputs():

    _w = (lambda a: (lambda t: t.to(torch.bfloat16) if t.is_floating_point() else t)(torch.as_tensor(a)))
    def _A_setup():
        B, L, D, N = 1, 2048, 512, 128
        A_re = -(lambda _x: torch.exp(torch.as_tensor(_x)))((lambda *s: torch.randn(*s, dtype=torch.bfloat16) * 3.2)(D, N))
        A_im = torch.pi * (lambda *s: torch.randn(*s, dtype=torch.bfloat16) * 0.05)(D, N)
        B_re = (lambda *s: torch.randn(*s, dtype=torch.bfloat16) * 0.1)(D, N)
        B_im = (lambda *s: torch.randn(*s, dtype=torch.bfloat16) * 0.1)(D, N)
        C_re = (lambda *s: torch.randn(*s, dtype=torch.bfloat16) * 0.1)(D, N)
        C_im = (lambda *s: torch.randn(*s, dtype=torch.bfloat16) * 0.1)(D, N)
        log_dt = (lambda *s: torch.randn(*s, dtype=torch.bfloat16) * 0.05)(D) * 0.5 - 4.0
        Dskip = (lambda *s: torch.randn(*s, dtype=torch.bfloat16) * 0.05)(D)
        return {
            "u": _w((lambda *s: torch.randn(*s, dtype=torch.bfloat16) * 0.05)(B, L, D)),
            "A_re": _w(A_re),
            "A_im": _w(A_im),
            "B_re": _w(B_re),
            "B_im": _w(B_im),
            "C_re": _w(C_re),
            "C_im": _w(C_im),
            "log_dt": _w(log_dt),
            "Dskip": _w(Dskip),
        }
    _A_in = _A_setup()

    def _B_setup():
        B, S, D, F = 1, 2048, 512, 1792
        return {
            "x": _w((lambda *s: torch.randn(*s, dtype=torch.bfloat16) * 0.05)(B, S, D)),
            "w1": _w((lambda *s: torch.randn(*s, dtype=torch.bfloat16) * 1.6)(D, F) * (D ** -0.5)),
            "b1": _w((lambda *s: torch.randn(*s, dtype=torch.bfloat16) * 0.8)(F)),
            "w2": _w((lambda *s: torch.randn(*s, dtype=torch.bfloat16) * 0.05)(F, D) * (F ** -0.5)),
            "b2": _w((lambda *s: torch.randn(*s, dtype=torch.bfloat16) * 0.05)(D)),
        }
    _B_in = _B_setup()

    return {
        "A_u": _A_in["u"],
        "A_A_re": _A_in["A_re"],
        "A_A_im": _A_in["A_im"],
        "A_B_re": _A_in["B_re"],
        "A_B_im": _A_in["B_im"],
        "A_C_re": _A_in["C_re"],
        "A_C_im": _A_in["C_im"],
        "A_log_dt": _A_in["log_dt"],
        "A_Dskip": _A_in["Dskip"],
        "B_x": _B_in["x"],
        "B_w1": _B_in["w1"],
        "B_b1": _B_in["b1"],
        "B_w2": _B_in["w2"],
        "B_b2": _B_in["b2"],
    }

def reference(A_u, A_A_re, A_A_im, A_B_re, A_B_im, A_C_re, A_C_im, A_log_dt, A_Dskip, B_x, B_w1, B_b1, B_w2, B_b2):
    def _A_ref(u, A_re, A_im, B_re, B_im, C_re, C_im, log_dt, Dskip):
        Bsz, L, D = u.shape
        dt = torch.exp(log_dt)[:, None]
        A = A_re + 1j * A_im
        Bc = B_re + 1j * B_im
        Cc = C_re + 1j * C_im
        logdA = dt * A
        dB = dt * Bc
        l = (lambda x, dt: x.to(dt))(torch.arange(L), A_re.dtype)
        P = torch.exp(logdA[:, :, None] * l[None, None, :])
        K = torch.einsum("dn,dnl,dn->dl", Cc, P, dB).real
        L2 = 2 * L
        Kp = _pad(K, ((0, 0), (0, L)))
        up = (lambda x, *d: x.permute(*d))(u, 0, 2, 1)
        up = _pad(up, ((0, 0), (0, 0), (0, L)))
        Kf = (lambda x, axes=(-2,-1): torch.fft.rfft2(x.float(), dim=axes))(Kp[:, None, :], axes=(-2, -1))
        Uf = (lambda x, axes=(-2,-1): torch.fft.rfft2(x.float(), dim=axes))(up[:, :, None, :], axes=(-2, -1))
        Yf = Uf * Kf[None, :, :, :]
        y = (lambda x, s, axes=(-2,-1): torch.fft.irfft2(x, s=s, dim=axes).to(torch.bfloat16))(Yf, (1, L2), axes=(-2, -1))[:, :, 0, :L]
        y = (lambda x, *d: x.permute(*d))(y, 0, 2, 1) + u * Dskip[None, None, :]
        return y

    def _B_ref(x, w1, b1, w2, b2):
        y = _layernorm(x, axis=-1)
        h = _gelu(torch.einsum("bsd,df->bsf", y, w1) + b1)
        return torch.einsum("bsf,fd->bsd", h, w2) + b2

    x = A_u
    xn = _layernorm(x, axis=-1)
    return x + _A_ref(xn, A_A_re, A_A_im, A_B_re, A_B_im, A_C_re, A_C_im, A_log_dt, A_Dskip) + _B_ref(xn, B_w1, B_b1, B_w2, B_b2)
```

```asm
; @launch kernel=k1_kernel grid=(1216,1,1) block=(256,1,1) lds=33280
; @launch kernel=k2_kernel grid=(736,1,1) block=(256,1,1) lds=65536
; @launch kernel=k3_kernel grid=(256,1,1) block=(512,1,1) lds=147456
.amdgcn_target "amdgcn-amd-amdhsa--gfx950"
.text
.globl k1_kernel
.p2align 8
.type k1_kernel,@function
k1_kernel:
    s_cmp_ge_u32 s2, 1216
    s_cbranch_scc1 k1_end_3
    s_load_dwordx2 s[4:5], s[0:1], 0
    s_load_dwordx2 s[6:7], s[0:1], 128
    s_waitcnt lgkmcnt(0)
    s_mov_b32 s8, s4
    s_mov_b32 s9, s5
    s_mov_b32 s10, 2097152
    s_mov_b32 s11, 0x00020000
    s_mov_b32 s12, s6
    s_mov_b32 s13, s7
    s_mov_b32 s14, 268435456
    s_mov_b32 s15, 0x00020000
    s_cmp_ge_u32 s2, 256
    s_cbranch_scc1 k1_kg_1
    v_lshrrev_b32 v1, 6, v0
    v_and_b32 v2, 63, v0
    s_lshl_b32 s3, s2, 3
    v_lshlrev_b32 v3, 1, v1
    v_add_u32 v3, s3, v3
    v_lshlrev_b32 v4, 10, v3
    v_lshl_add_u32 v4, v2, 4, v4
    v_add_u32 v9, 0, v4
    buffer_load_dwordx4 v[16:19], v9, s[8:11], 0 offen
    v_add_u32 v9, 1024, v4
    buffer_load_dwordx4 v[20:23], v9, s[8:11], 0 offen
    v_lshlrev_b32 v5, 1, v1
    s_movk_i32 s4, 1040
    v_mul_lo_u32 v5, v5, s4
    v_lshl_add_u32 v5, v2, 4, v5
    v_add_u32 v6, 0x200000, v4
    s_waitcnt vmcnt(0)
    v_lshlrev_b32 v48, 16, v16
    v_and_b32 v49, 0xffff0000, v16
    v_lshlrev_b32 v50, 16, v17
    v_and_b32 v51, 0xffff0000, v17
    v_lshlrev_b32 v52, 16, v18
    v_and_b32 v53, 0xffff0000, v18
    v_lshlrev_b32 v54, 16, v19
    v_and_b32 v55, 0xffff0000, v19
    v_add_f32 v72, v48, v49
    v_add_f32 v72, v72, v50
    v_add_f32 v72, v72, v51
    v_add_f32 v72, v72, v52
    v_add_f32 v72, v72, v53
    v_add_f32 v72, v72, v54
    v_add_f32 v72, v72, v55
    s_nop 1
    v_add_f32_dpp v72, v72, v72 row_shr:1 row_mask:0xf bank_mask:0xf bound_ctrl:0
    s_nop 1
    v_add_f32_dpp v72, v72, v72 row_shr:2 row_mask:0xf bank_mask:0xf bound_ctrl:0
    s_nop 1
    v_add_f32_dpp v72, v72, v72 row_shr:4 row_mask:0xf bank_mask:0xf bound_ctrl:0
    s_nop 1
    v_add_f32_dpp v72, v72, v72 row_shr:8 row_mask:0xf bank_mask:0xf bound_ctrl:0
    s_nop 1
    v_add_f32_dpp v72, v72, v72 row_bcast:15 row_mask:0xa bank_mask:0xf
    s_nop 1
    v_add_f32_dpp v72, v72, v72 row_bcast:31 row_mask:0xc bank_mask:0xf
    s_nop 1
    v_readlane_b32 s20, v72, 63
    s_nop 3
    v_mov_b32 v72, s20
    v_mul_f32 v72, 0x3b000000, v72
    v_sub_f32 v73, v48, v72
    v_mul_f32 v74, v73, v73
    v_sub_f32 v73, v49, v72
    v_fmac_f32 v74, v73, v73
    v_sub_f32 v73, v50, v72
    v_fmac_f32 v74, v73, v73
    v_sub_f32 v73, v51, v72
    v_fmac_f32 v74, v73, v73
    v_sub_f32 v73, v52, v72
    v_fmac_f32 v74, v73, v73
    v_sub_f32 v73, v53, v72
    v_fmac_f32 v74, v73, v73
    v_sub_f32 v73, v54, v72
    v_fmac_f32 v74, v73, v73
    v_sub_f32 v73, v55, v72
    v_fmac_f32 v74, v73, v73
    s_nop 1
    v_add_f32_dpp v74, v74, v74 row_shr:1 row_mask:0xf bank_mask:0xf bound_ctrl:0
    s_nop 1
    v_add_f32_dpp v74, v74, v74 row_shr:2 row_mask:0xf bank_mask:0xf bound_ctrl:0
    s_nop 1
    v_add_f32_dpp v74, v74, v74 row_shr:4 row_mask:0xf bank_mask:0xf bound_ctrl:0
    s_nop 1
    v_add_f32_dpp v74, v74, v74 row_shr:8 row_mask:0xf bank_mask:0xf bound_ctrl:0
    s_nop 1
    v_add_f32_dpp v74, v74, v74 row_bcast:15 row_mask:0xa bank_mask:0xf
    s_nop 1
    v_add_f32_dpp v74, v74, v74 row_bcast:31 row_mask:0xc bank_mask:0xf
    s_nop 1
    v_readlane_b32 s20, v74, 63
    s_nop 3
    v_mov_b32 v74, s20
    v_mul_f32 v74, 0x3b000000, v74
    v_cvt_pk_bf16_f32 v74, v74, v74
    v_lshlrev_b32 v74, 16, v74
    v_add_f32 v74, 0x3727c5ac, v74
    v_cvt_pk_bf16_f32 v74, v74, v74
    v_lshlrev_b32 v74, 16, v74
    v_sqrt_f32 v74, v74
    s_nop 0
    v_cvt_pk_bf16_f32 v74, v74, v74
    v_lshlrev_b32 v74, 16, v74
    v_rcp_f32 v75, v74
    s_nop 0
    v_fma_f32 v73, -v74, v75, 1.0
    v_fma_f32 v75, v73, v75, v75
    v_cvt_pk_bf16_f32 v72, v72, v72
    v_lshlrev_b32 v72, 16, v72
    v_sub_f32 v73, v48, v72
    v_cvt_pk_bf16_f32 v73, v73, v73
    v_lshlrev_b32 v73, 16, v73
    v_mul_f32 v56, v73, v75
    v_fma_f32 v73, -v74, v56, v73
    v_fma_f32 v56, v73, v75, v56
    v_cvt_pk_bf16_f32 v56, v56, v56
    v_lshlrev_b32 v56, 16, v56
    v_sub_f32 v73, v49, v72
    v_cvt_pk_bf16_f32 v73, v73, v73
    v_lshlrev_b32 v73, 16, v73
    v_mul_f32 v57, v73, v75
    v_fma_f32 v73, -v74, v57, v73
    v_fma_f32 v57, v73, v75, v57
    v_cvt_pk_bf16_f32 v57, v57, v57
    v_lshlrev_b32 v57, 16, v57
    v_sub_f32 v73, v50, v72
    v_cvt_pk_bf16_f32 v73, v73, v73
    v_lshlrev_b32 v73, 16, v73
    v_mul_f32 v58, v73, v75
    v_fma_f32 v73, -v74, v58, v73
    v_fma_f32 v58, v73, v75, v58
    v_cvt_pk_bf16_f32 v58, v58, v58
    v_lshlrev_b32 v58, 16, v58
    v_sub_f32 v73, v51, v72
    v_cvt_pk_bf16_f32 v73, v73, v73
    v_lshlrev_b32 v73, 16, v73
    v_mul_f32 v59, v73, v75
    v_fma_f32 v73, -v74, v59, v73
    v_fma_f32 v59, v73, v75, v59
    v_cvt_pk_bf16_f32 v59, v59, v59
    v_lshlrev_b32 v59, 16, v59
    v_sub_f32 v73, v52, v72
    v_cvt_pk_bf16_f32 v73, v73, v73
    v_lshlrev_b32 v73, 16, v73
    v_mul_f32 v60, v73, v75
    v_fma_f32 v73, -v74, v60, v73
    v_fma_f32 v60, v73, v75, v60
    v_cvt_pk_bf16_f32 v60, v60, v60
    v_lshlrev_b32 v60, 16, v60
    v_sub_f32 v73, v53, v72
    v_cvt_pk_bf16_f32 v73, v73, v73
    v_lshlrev_b32 v73, 16, v73
    v_mul_f32 v61, v73, v75
    v_fma_f32 v73, -v74, v61, v73
    v_fma_f32 v61, v73, v75, v61
    v_cvt_pk_bf16_f32 v61, v61, v61
    v_lshlrev_b32 v61, 16, v61
    v_sub_f32 v73, v54, v72
    v_cvt_pk_bf16_f32 v73, v73, v73
    v_lshlrev_b32 v73, 16, v73
    v_mul_f32 v62, v73, v75
    v_fma_f32 v73, -v74, v62, v73
    v_fma_f32 v62, v73, v75, v62
    v_cvt_pk_bf16_f32 v62, v62, v62
    v_lshlrev_b32 v62, 16, v62
    v_sub_f32 v73, v55, v72
    v_cvt_pk_bf16_f32 v73, v73, v73
    v_lshlrev_b32 v73, 16, v73
    v_mul_f32 v63, v73, v75
    v_fma_f32 v73, -v74, v63, v73
    v_fma_f32 v63, v73, v75, v63
    v_cvt_pk_bf16_f32 v63, v63, v63
    v_lshlrev_b32 v63, 16, v63
    v_add_f32 v72, v56, v57
    v_add_f32 v72, v72, v58
    v_add_f32 v72, v72, v59
    v_add_f32 v72, v72, v60
    v_add_f32 v72, v72, v61
    v_add_f32 v72, v72, v62
    v_add_f32 v72, v72, v63
    s_nop 1
    v_add_f32_dpp v72, v72, v72 row_shr:1 row_mask:0xf bank_mask:0xf bound_ctrl:0
    s_nop 1
    v_add_f32_dpp v72, v72, v72 row_shr:2 row_mask:0xf bank_mask:0xf bound_ctrl:0
    s_nop 1
    v_add_f32_dpp v72, v72, v72 row_shr:4 row_mask:0xf bank_mask:0xf bound_ctrl:0
    s_nop 1
    v_add_f32_dpp v72, v72, v72 row_shr:8 row_mask:0xf bank_mask:0xf bound_ctrl:0
    s_nop 1
    v_add_f32_dpp v72, v72, v72 row_bcast:15 row_mask:0xa bank_mask:0xf
    s_nop 1
    v_add_f32_dpp v72, v72, v72 row_bcast:31 row_mask:0xc bank_mask:0xf
    s_nop 1
    v_readlane_b32 s20, v72, 63
    s_nop 3
    v_mov_b32 v72, s20
    v_mul_f32 v72, 0x3b000000, v72
    v_sub_f32 v73, v56, v72
    v_mul_f32 v74, v73, v73
    v_sub_f32 v73, v57, v72
    v_fmac_f32 v74, v73, v73
    v_sub_f32 v73, v58, v72
    v_fmac_f32 v74, v73, v73
    v_sub_f32 v73, v59, v72
    v_fmac_f32 v74, v73, v73
    v_sub_f32 v73, v60, v72
    v_fmac_f32 v74, v73, v73
    v_sub_f32 v73, v61, v72
    v_fmac_f32 v74, v73, v73
    v_sub_f32 v73, v62, v72
    v_fmac_f32 v74, v73, v73
    v_sub_f32 v73, v63, v72
    v_fmac_f32 v74, v73, v73
    s_nop 1
    v_add_f32_dpp v74, v74, v74 row_shr:1 row_mask:0xf bank_mask:0xf bound_ctrl:0
    s_nop 1
    v_add_f32_dpp v74, v74, v74 row_shr:2 row_mask:0xf bank_mask:0xf bound_ctrl:0
    s_nop 1
    v_add_f32_dpp v74, v74, v74 row_shr:4 row_mask:0xf bank_mask:0xf bound_ctrl:0
    s_nop 1
    v_add_f32_dpp v74, v74, v74 row_shr:8 row_mask:0xf bank_mask:0xf bound_ctrl:0
    s_nop 1
    v_add_f32_dpp v74, v74, v74 row_bcast:15 row_mask:0xa bank_mask:0xf
    s_nop 1
    v_add_f32_dpp v74, v74, v74 row_bcast:31 row_mask:0xc bank_mask:0xf
    s_nop 1
    v_readlane_b32 s20, v74, 63
    s_nop 3
    v_mov_b32 v74, s20
    v_mul_f32 v74, 0x3b000000, v74
    v_cvt_pk_bf16_f32 v74, v74, v74
    v_lshlrev_b32 v74, 16, v74
    v_add_f32 v74, 0x3727c5ac, v74
    v_cvt_pk_bf16_f32 v74, v74, v74
    v_lshlrev_b32 v74, 16, v74
    v_sqrt_f32 v74, v74
    s_nop 0
    v_cvt_pk_bf16_f32 v74, v74, v74
    v_lshlrev_b32 v74, 16, v74
    v_rcp_f32 v75, v74
    s_nop 0
    v_fma_f32 v73, -v74, v75, 1.0
    v_fma_f32 v75, v73, v75, v75
    v_cvt_pk_bf16_f32 v72, v72, v72
    v_lshlrev_b32 v72, 16, v72
    v_sub_f32 v73, v56, v72
    v_cvt_pk_bf16_f32 v73, v73, v73
    v_lshlrev_b32 v73, 16, v73
    v_mul_f32 v64, v73, v75
    v_fma_f32 v73, -v74, v64, v73
    v_fma_f32 v64, v73, v75, v64
    v_cvt_pk_bf16_f32 v64, v64, v64
    v_lshlrev_b32 v64, 16, v64
    v_sub_f32 v73, v57, v72
    v_cvt_pk_bf16_f32 v73, v73, v73
    v_lshlrev_b32 v73, 16, v73
    v_mul_f32 v65, v73, v75
    v_fma_f32 v73, -v74, v65, v73
    v_fma_f32 v65, v73, v75, v65
    v_cvt_pk_bf16_f32 v65, v65, v65
    v_lshlrev_b32 v65, 16, v65
    v_sub_f32 v73, v58, v72
    v_cvt_pk_bf16_f32 v73, v73, v73
    v_lshlrev_b32 v73, 16, v73
    v_mul_f32 v66, v73, v75
    v_fma_f32 v73, -v74, v66, v73
    v_fma_f32 v66, v73, v75, v66
    v_cvt_pk_bf16_f32 v66, v66, v66
    v_lshlrev_b32 v66, 16, v66
    v_sub_f32 v73, v59, v72
    v_cvt_pk_bf16_f32 v73, v73, v73
    v_lshlrev_b32 v73, 16, v73
    v_mul_f32 v67, v73, v75
    v_fma_f32 v73, -v74, v67, v73
    v_fma_f32 v67, v73, v75, v67
    v_cvt_pk_bf16_f32 v67, v67, v67
    v_lshlrev_b32 v67, 16, v67
    v_sub_f32 v73, v60, v72
    v_cvt_pk_bf16_f32 v73, v73, v73
    v_lshlrev_b32 v73, 16, v73
    v_mul_f32 v68, v73, v75
    v_fma_f32 v73, -v74, v68, v73
    v_fma_f32 v68, v73, v75, v68
    v_cvt_pk_bf16_f32 v68, v68, v68
    v_lshlrev_b32 v68, 16, v68
    v_sub_f32 v73, v61, v72
    v_cvt_pk_bf16_f32 v73, v73, v73
    v_lshlrev_b32 v73, 16, v73
    v_mul_f32 v69, v73, v75
    v_fma_f32 v73, -v74, v69, v73
    v_fma_f32 v69, v73, v75, v69
    v_cvt_pk_bf16_f32 v69, v69, v69
    v_lshlrev_b32 v69, 16, v69
    v_sub_f32 v73, v62, v72
    v_cvt_pk_bf16_f32 v73, v73, v73
    v_lshlrev_b32 v73, 16, v73
    v_mul_f32 v70, v73, v75
    v_fma_f32 v73, -v74, v70, v73
    v_fma_f32 v70, v73, v75, v70
    v_cvt_pk_bf16_f32 v70, v70, v70
    v_lshlrev_b32 v70, 16, v70
    v_sub_f32 v73, v63, v72
    v_cvt_pk_bf16_f32 v73, v73, v73
    v_lshlrev_b32 v73, 16, v73
    v_mul_f32 v71, v73, v75
    v_fma_f32 v73, -v74, v71, v73
    v_fma_f32 v71, v73, v75, v71
    v_cvt_pk_bf16_f32 v71, v71, v71
    v_lshlrev_b32 v71, 16, v71
    v_cvt_pk_bf16_f32 v76, v56, v57
    v_cvt_pk_bf16_f32 v80, v64, v65
    v_cvt_pk_bf16_f32 v77, v58, v59
    v_cvt_pk_bf16_f32 v81, v66, v67
    v_cvt_pk_bf16_f32 v78, v60, v61
    v_cvt_pk_bf16_f32 v82, v68, v69
    v_cvt_pk_bf16_f32 v79, v62, v63
    v_cvt_pk_bf16_f32 v83, v70, v71
    ds_write_b128 v5, v[76:79] offset:0
    v_add_u32 v9, 0, v6
    buffer_store_dwordx4 v[80:83], v9, s[12:15], 0 offen
    s_nop 1
    v_lshlrev_b32 v48, 16, v20
    v_and_b32 v49, 0xffff0000, v20
    v_lshlrev_b32 v50, 16, v21
    v_and_b32 v51, 0xffff0000, v21
    v_lshlrev_b32 v52, 16, v22
    v_and_b32 v53, 0xffff0000, v22
    v_lshlrev_b32 v54, 16, v23
    v_and_b32 v55, 0xffff0000, v23
    v_add_f32 v72, v48, v49
    v_add_f32 v72, v72, v50
    v_add_f32 v72, v72, v51
    v_add_f32 v72, v72, v52
    v_add_f32 v72, v72, v53
    v_add_f32 v72, v72, v54
    v_add_f32 v72, v72, v55
    s_nop 1
    v_add_f32_dpp v72, v72, v72 row_shr:1 row_mask:0xf bank_mask:0xf bound_ctrl:0
    s_nop 1
    v_add_f32_dpp v72, v72, v72 row_shr:2 row_mask:0xf bank_mask:0xf bound_ctrl:0
    s_nop 1
    v_add_f32_dpp v72, v72, v72 row_shr:4 row_mask:0xf bank_mask:0xf bound_ctrl:0
    s_nop 1
    v_add_f32_dpp v72, v72, v72 row_shr:8 row_mask:0xf bank_mask:0xf bound_ctrl:0
    s_nop 1
    v_add_f32_dpp v72, v72, v72 row_bcast:15 row_mask:0xa bank_mask:0xf
    s_nop 1
    v_add_f32_dpp v72, v72, v72 row_bcast:31 row_mask:0xc bank_mask:0xf
    s_nop 1
    v_readlane_b32 s20, v72, 63
    s_nop 3
    v_mov_b32 v72, s20
    v_mul_f32 v72, 0x3b000000, v72
    v_sub_f32 v73, v48, v72
    v_mul_f32 v74, v73, v73
    v_sub_f32 v73, v49, v72
    v_fmac_f32 v74, v73, v73
    v_sub_f32 v73, v50, v72
    v_fmac_f32 v74, v73, v73
    v_sub_f32 v73, v51, v72
    v_fmac_f32 v74, v73, v73
    v_sub_f32 v73, v52, v72
    v_fmac_f32 v74, v73, v73
    v_sub_f32 v73, v53, v72
    v_fmac_f32 v74, v73, v73
    v_sub_f32 v73, v54, v72
    v_fmac_f32 v74, v73, v73
    v_sub_f32 v73, v55, v72
    v_fmac_f32 v74, v73, v73
    s_nop 1
    v_add_f32_dpp v74, v74, v74 row_shr:1 row_mask:0xf bank_mask:0xf bound_ctrl:0
    s_nop 1
    v_add_f32_dpp v74, v74, v74 row_shr:2 row_mask:0xf bank_mask:0xf bound_ctrl:0
    s_nop 1
    v_add_f32_dpp v74, v74, v74 row_shr:4 row_mask:0xf bank_mask:0xf bound_ctrl:0
    s_nop 1
    v_add_f32_dpp v74, v74, v74 row_shr:8 row_mask:0xf bank_mask:0xf bound_ctrl:0
    s_nop 1
    v_add_f32_dpp v74, v74, v74 row_bcast:15 row_mask:0xa bank_mask:0xf
    s_nop 1
    v_add_f32_dpp v74, v74, v74 row_bcast:31 row_mask:0xc bank_mask:0xf
    s_nop 1
    v_readlane_b32 s20, v74, 63
    s_nop 3
    v_mov_b32 v74, s20
    v_mul_f32 v74, 0x3b000000, v74
    v_cvt_pk_bf16_f32 v74, v74, v74
    v_lshlrev_b32 v74, 16, v74
    v_add_f32 v74, 0x3727c5ac, v74
    v_cvt_pk_bf16_f32 v74, v74, v74
    v_lshlrev_b32 v74, 16, v74
    v_sqrt_f32 v74, v74
    s_nop 0
    v_cvt_pk_bf16_f32 v74, v74, v74
    v_lshlrev_b32 v74, 16, v74
    v_rcp_f32 v75, v74
    s_nop 0
    v_fma_f32 v73, -v74, v75, 1.0
    v_fma_f32 v75, v73, v75, v75
    v_cvt_pk_bf16_f32 v72, v72, v72
    v_lshlrev_b32 v72, 16, v72
    v_sub_f32 v73, v48, v72
    v_cvt_pk_bf16_f32 v73, v73, v73
    v_lshlrev_b32 v73, 16, v73
    v_mul_f32 v56, v73, v75
    v_fma_f32 v73, -v74, v56, v73
    v_fma_f32 v56, v73, v75, v56
    v_cvt_pk_bf16_f32 v56, v56, v56
    v_lshlrev_b32 v56, 16, v56
    v_sub_f32 v73, v49, v72
    v_cvt_pk_bf16_f32 v73, v73, v73
    v_lshlrev_b32 v73, 16, v73
    v_mul_f32 v57, v73, v75
    v_fma_f32 v73, -v74, v57, v73
    v_fma_f32 v57, v73, v75, v57
    v_cvt_pk_bf16_f32 v57, v57, v57
    v_lshlrev_b32 v57, 16, v57
    v_sub_f32 v73, v50, v72
    v_cvt_pk_bf16_f32 v73, v73, v73
    v_lshlrev_b32 v73, 16, v73
    v_mul_f32 v58, v73, v75
    v_fma_f32 v73, -v74, v58, v73
    v_fma_f32 v58, v73, v75, v58
    v_cvt_pk_bf16_f32 v58, v58, v58
    v_lshlrev_b32 v58, 16, v58
    v_sub_f32 v73, v51, v72
    v_cvt_pk_bf16_f32 v73, v73, v73
    v_lshlrev_b32 v73, 16, v73
    v_mul_f32 v59, v73, v75
    v_fma_f32 v73, -v74, v59, v73
    v_fma_f32 v59, v73, v75, v59
    v_cvt_pk_bf16_f32 v59, v59, v59
    v_lshlrev_b32 v59, 16, v59
    v_sub_f32 v73, v52, v72
    v_cvt_pk_bf16_f32 v73, v73, v73
    v_lshlrev_b32 v73, 16, v73
    v_mul_f32 v60, v73, v75
    v_fma_f32 v73, -v74, v60, v73
    v_fma_f32 v60, v73, v75, v60
    v_cvt_pk_bf16_f32 v60, v60, v60
    v_lshlrev_b32 v60, 16, v60
    v_sub_f32 v73, v53, v72
    v_cvt_pk_bf16_f32 v73, v73, v73
    v_lshlrev_b32 v73, 16, v73
    v_mul_f32 v61, v73, v75
    v_fma_f32 v73, -v74, v61, v73
    v_fma_f32 v61, v73, v75, v61
    v_cvt_pk_bf16_f32 v61, v61, v61
    v_lshlrev_b32 v61, 16, v61
    v_sub_f32 v73, v54, v72
    v_cvt_pk_bf16_f32 v73, v73, v73
    v_lshlrev_b32 v73, 16, v73
    v_mul_f32 v62, v73, v75
    v_fma_f32 v73, -v74, v62, v73
    v_fma_f32 v62, v73, v75, v62
    v_cvt_pk_bf16_f32 v62, v62, v62
    v_lshlrev_b32 v62, 16, v62
    v_sub_f32 v73, v55, v72
    v_cvt_pk_bf16_f32 v73, v73, v73
    v_lshlrev_b32 v73, 16, v73
    v_mul_f32 v63, v73, v75
    v_fma_f32 v73, -v74, v63, v73
    v_fma_f32 v63, v73, v75, v63
    v_cvt_pk_bf16_f32 v63, v63, v63
    v_lshlrev_b32 v63, 16, v63
    v_add_f32 v72, v56, v57
    v_add_f32 v72, v72, v58
    v_add_f32 v72, v72, v59
    v_add_f32 v72, v72, v60
    v_add_f32 v72, v72, v61
    v_add_f32 v72, v72, v62
    v_add_f32 v72, v72, v63
    s_nop 1
    v_add_f32_dpp v72, v72, v72 row_shr:1 row_mask:0xf bank_mask:0xf bound_ctrl:0
    s_nop 1
    v_add_f32_dpp v72, v72, v72 row_shr:2 row_mask:0xf bank_mask:0xf bound_ctrl:0
    s_nop 1
    v_add_f32_dpp v72, v72, v72 row_shr:4 row_mask:0xf bank_mask:0xf bound_ctrl:0
    s_nop 1
    v_add_f32_dpp v72, v72, v72 row_shr:8 row_mask:0xf bank_mask:0xf bound_ctrl:0
    s_nop 1
    v_add_f32_dpp v72, v72, v72 row_bcast:15 row_mask:0xa bank_mask:0xf
    s_nop 1
    v_add_f32_dpp v72, v72, v72 row_bcast:31 row_mask:0xc bank_mask:0xf
    s_nop 1
    v_readlane_b32 s20, v72, 63
    s_nop 3
    v_mov_b32 v72, s20
    v_mul_f32 v72, 0x3b000000, v72
    v_sub_f32 v73, v56, v72
    v_mul_f32 v74, v73, v73
    v_sub_f32 v73, v57, v72
    v_fmac_f32 v74, v73, v73
    v_sub_f32 v73, v58, v72
    v_fmac_f32 v74, v73, v73
    v_sub_f32 v73, v59, v72
    v_fmac_f32 v74, v73, v73
    v_sub_f32 v73, v60, v72
    v_fmac_f32 v74, v73, v73
    v_sub_f32 v73, v61, v72
    v_fmac_f32 v74, v73, v73
    v_sub_f32 v73, v62, v72
    v_fmac_f32 v74, v73, v73
    v_sub_f32 v73, v63, v72
    v_fmac_f32 v74, v73, v73
    s_nop 1
    v_add_f32_dpp v74, v74, v74 row_shr:1 row_mask:0xf bank_mask:0xf bound_ctrl:0
    s_nop 1
    v_add_f32_dpp v74, v74, v74 row_shr:2 row_mask:0xf bank_mask:0xf bound_ctrl:0
    s_nop 1
    v_add_f32_dpp v74, v74, v74 row_shr:4 row_mask:0xf bank_mask:0xf bound_ctrl:0
    s_nop 1
    v_add_f32_dpp v74, v74, v74 row_shr:8 row_mask:0xf bank_mask:0xf bound_ctrl:0
    s_nop 1
    v_add_f32_dpp v74, v74, v74 row_bcast:15 row_mask:0xa bank_mask:0xf
    s_nop 1
    v_add_f32_dpp v74, v74, v74 row_bcast:31 row_mask:0xc bank_mask:0xf
    s_nop 1
    v_readlane_b32 s20, v74, 63
    s_nop 3
    v_mov_b32 v74, s20
    v_mul_f32 v74, 0x3b000000, v74
    v_cvt_pk_bf16_f32 v74, v74, v74
    v_lshlrev_b32 v74, 16, v74
    v_add_f32 v74, 0x3727c5ac, v74
    v_cvt_pk_bf16_f32 v74, v74, v74
    v_lshlrev_b32 v74, 16, v74
    v_sqrt_f32 v74, v74
    s_nop 0
    v_cvt_pk_bf16_f32 v74, v74, v74
    v_lshlrev_b32 v74, 16, v74
    v_rcp_f32 v75, v74
    s_nop 0
    v_fma_f32 v73, -v74, v75, 1.0
    v_fma_f32 v75, v73, v75, v75
    v_cvt_pk_bf16_f32 v72, v72, v72
    v_lshlrev_b32 v72, 16, v72
    v_sub_f32 v73, v56, v72
    v_cvt_pk_bf16_f32 v73, v73, v73
    v_lshlrev_b32 v73, 16, v73
    v_mul_f32 v64, v73, v75
    v_fma_f32 v73, -v74, v64, v73
    v_fma_f32 v64, v73, v75, v64
    v_cvt_pk_bf16_f32 v64, v64, v64
    v_lshlrev_b32 v64, 16, v64
    v_sub_f32 v73, v57, v72
    v_cvt_pk_bf16_f32 v73, v73, v73
    v_lshlrev_b32 v73, 16, v73
    v_mul_f32 v65, v73, v75
    v_fma_f32 v73, -v74, v65, v73
    v_fma_f32 v65, v73, v75, v65
    v_cvt_pk_bf16_f32 v65, v65, v65
    v_lshlrev_b32 v65, 16, v65
    v_sub_f32 v73, v58, v72
    v_cvt_pk_bf16_f32 v73, v73, v73
    v_lshlrev_b32 v73, 16, v73
    v_mul_f32 v66, v73, v75
    v_fma_f32 v73, -v74, v66, v73
    v_fma_f32 v66, v73, v75, v66
    v_cvt_pk_bf16_f32 v66, v66, v66
    v_lshlrev_b32 v66, 16, v66
    v_sub_f32 v73, v59, v72
    v_cvt_pk_bf16_f32 v73, v73, v73
    v_lshlrev_b32 v73, 16, v73
    v_mul_f32 v67, v73, v75
    v_fma_f32 v73, -v74, v67, v73
    v_fma_f32 v67, v73, v75, v67
    v_cvt_pk_bf16_f32 v67, v67, v67
    v_lshlrev_b32 v67, 16, v67
    v_sub_f32 v73, v60, v72
    v_cvt_pk_bf16_f32 v73, v73, v73
    v_lshlrev_b32 v73, 16, v73
    v_mul_f32 v68, v73, v75
    v_fma_f32 v73, -v74, v68, v73
    v_fma_f32 v68, v73, v75, v68
    v_cvt_pk_bf16_f32 v68, v68, v68
    v_lshlrev_b32 v68, 16, v68
    v_sub_f32 v73, v61, v72
    v_cvt_pk_bf16_f32 v73, v73, v73
    v_lshlrev_b32 v73, 16, v73
    v_mul_f32 v69, v73, v75
    v_fma_f32 v73, -v74, v69, v73
    v_fma_f32 v69, v73, v75, v69
    v_cvt_pk_bf16_f32 v69, v69, v69
    v_lshlrev_b32 v69, 16, v69
    v_sub_f32 v73, v62, v72
    v_cvt_pk_bf16_f32 v73, v73, v73
    v_lshlrev_b32 v73, 16, v73
    v_mul_f32 v70, v73, v75
    v_fma_f32 v73, -v74, v70, v73
    v_fma_f32 v70, v73, v75, v70
    v_cvt_pk_bf16_f32 v70, v70, v70
    v_lshlrev_b32 v70, 16, v70
    v_sub_f32 v73, v63, v72
    v_cvt_pk_bf16_f32 v73, v73, v73
    v_lshlrev_b32 v73, 16, v73
    v_mul_f32 v71, v73, v75
    v_fma_f32 v73, -v74, v71, v73
    v_fma_f32 v71, v73, v75, v71
    v_cvt_pk_bf16_f32 v71, v71, v71
    v_lshlrev_b32 v71, 16, v71
    v_cvt_pk_bf16_f32 v76, v56, v57
    v_cvt_pk_bf16_f32 v80, v64, v65
    v_cvt_pk_bf16_f32 v77, v58, v59
    v_cvt_pk_bf16_f32 v81, v66, v67
    v_cvt_pk_bf16_f32 v78, v60, v61
    v_cvt_pk_bf16_f32 v82, v68, v69
    v_cvt_pk_bf16_f32 v79, v62, v63
    v_cvt_pk_bf16_f32 v83, v70, v71
    ds_write_b128 v5, v[76:79] offset:1040
    v_add_u32 v9, 1024, v6
    buffer_store_dwordx4 v[80:83], v9, s[12:15], 0 offen
    s_nop 1
    s_waitcnt lgkmcnt(0)
    s_barrier
    v_lshlrev_b32 v7, 1, v0
    v_lshlrev_b32 v8, 12, v0
    s_lshl_b32 s4, s2, 4
    v_add_u32 v8, s4, v8
    ds_read_u16 v16, v7 offset:0
    ds_read_u16 v20, v7 offset:1040
    ds_read_u16 v17, v7 offset:2080
    ds_read_u16 v21, v7 offset:3120
    ds_read_u16 v18, v7 offset:4160
    ds_read_u16 v22, v7 offset:5200
    ds_read_u16 v19, v7 offset:6240
    ds_read_u16 v23, v7 offset:7280
    s_waitcnt lgkmcnt(0)
    v_lshl_or_b32 v16, v20, 16, v16
    v_lshl_or_b32 v17, v21, 16, v17
    v_lshl_or_b32 v18, v22, 16, v18
    v_lshl_or_b32 v19, v23, 16, v19
    buffer_store_dwordx4 v[16:19], v8, s[12:15], 0 offen offset:0
    s_nop 1
    v_add_u32 v8, 0x100000, v8
    ds_read_u16 v16, v7 offset:512
    ds_read_u16 v20, v7 offset:1552
    ds_read_u16 v17, v7 offset:2592
    ds_read_u16 v21, v7 offset:3632
    ds_read_u16 v18, v7 offset:4672
    ds_read_u16 v22, v7 offset:5712
    ds_read_u16 v19, v7 offset:6752
    ds_read_u16 v23, v7 offset:7792
    s_waitcnt lgkmcnt(0)
    v_lshl_or_b32 v16, v20, 16, v16
    v_lshl_or_b32 v17, v21, 16, v17
    v_lshl_or_b32 v18, v22, 16, v18
    v_lshl_or_b32 v19, v23, 16, v19
    buffer_store_dwordx4 v[16:19], v8, s[12:15], 0 offen offset:0
    s_nop 1
    s_waitcnt vmcnt(0)
    s_endpgm
k1_kg_1:
    s_sub_u32 s24, s2, 256
    s_cmp_ge_u32 s24, 512
    s_cbranch_scc1 k1_tr_2
    s_load_dwordx16 s[48:63], s[0:1], 8
    v_and_b32 v1, 127, v0
    s_lshl_b32 s25, s24, 8
    v_lshl_add_u32 v2, v1, 1, s25
    s_lshl_b32 s26, s24, 1
    v_mov_b32 v3, s26
    s_waitcnt lgkmcnt(0)
    global_load_ushort v10, v2, s[48:49]
    global_load_ushort v11, v2, s[50:51]
    global_load_ushort v12, v2, s[52:53]
    global_load_ushort v13, v2, s[54:55]
    global_load_ushort v14, v2, s[56:57]
    global_load_ushort v15, v2, s[58:59]
    global_load_ushort v16, v3, s[60:61]
    s_waitcnt vmcnt(0)
    v_lshlrev_b32 v10, 16, v10
    v_lshlrev_b32 v11, 16, v11
    v_lshlrev_b32 v12, 16, v12
    v_lshlrev_b32 v13, 16, v13
    v_lshlrev_b32 v14, 16, v14
    v_lshlrev_b32 v15, 16, v15
    v_lshlrev_b32 v16, 16, v16
    v_mul_f32 v16, 0x3fb8aa3b, v16
    v_exp_f32 v16, v16
    s_nop 0
    v_cvt_pk_bf16_f32 v16, v16, v16
    v_lshlrev_b32 v16, 16, v16
    v_mul_f32 v20, v10, v16
    v_mul_f32 v20, 0x3fb8aa3b, v20
    v_mul_f32 v21, v11, v16
    v_mul_f32 v21, 0.15915494, v21
    v_mul_f32 v12, v12, v16
    v_mul_f32 v13, v13, v16
    v_mul_f32 v22, v14, v12
    v_fma_f32 v22, -v15, v13, v22
    v_mul_f32 v23, v14, v13
    v_fma_f32 v23, v15, v12, v23
    v_lshlrev_b32 v4, 4, v1
    ds_write_b128 v4, v[20:23]
    s_waitcnt lgkmcnt(0)
    s_barrier
    v_lshrrev_b32 v1, 6, v0
    v_and_b32 v2, 15, v0
    v_bfe_u32 v3, v0, 4, 2
    v_cvt_f32_u32 v4, v2
    v_mul_f32 v5, 0x41800000, v4
    v_mul_f32 v6, 0x42000000, v4
    v_add_f32 v6, 0x43800000, v6
    v_lshlrev_b32 v7, 9, v1
    v_lshl_add_u32 v7, v3, 4, v7
    v_mov_b32 v64, 0
    v_mov_b32 v65, 0
    v_mov_b32 v66, 0
    v_mov_b32 v67, 0
    v_mov_b32 v68, 0
    v_mov_b32 v69, 0
    v_mov_b32 v70, 0
    v_mov_b32 v71, 0
    v_mov_b32 v72, 0
    v_mov_b32 v73, 0
    v_mov_b32 v74, 0
    v_mov_b32 v75, 0
    v_mov_b32 v76, 0
    v_mov_b32 v77, 0
    v_mov_b32 v78, 0
    v_mov_b32 v79, 0
    ds_read_b128 v[52:55], v7
    s_waitcnt lgkmcnt(0)
    v_mov_b32 v8, v52
    v_mov_b32 v9, v53
    v_mov_b32 v10, v54
    v_mov_b32 v11, v55
    ds_read_b128 v[52:55], v7 offset:64
    v_mul_f32 v30, v8, v4
    v_mul_f32 v31, v9, v4
    v_fract_f32 v31, v31
    v_exp_f32 v30, v30
    v_cos_f32 v32, v31
    v_sin_f32 v33, v31
    s_nop 0
    v_mul_f32 v32, v32, v30
    v_mul_f32 v33, v33, v30
    v_mul_f32 v34, v32, v32
    v_fma_f32 v34, -v33, v33, v34
    v_mul_f32 v35, v32, v33
    v_add_f32 v35, v35, v35
    v_mul_f32 v36, v34, v34
    v_fma_f32 v36, -v35, v35, v36
    v_mul_f32 v37, v34, v35
    v_add_f32 v37, v37, v37
    v_mul_f32 v38, v36, v36
    v_fma_f32 v38, -v37, v37, v38
    v_mul_f32 v39, v36, v37
    v_add_f32 v39, v39, v39
    v_mul_f32 v30, v8, v5
    v_mul_f32 v31, v9, v5
    v_fract_f32 v31, v31
    v_exp_f32 v30, v30
    v_cos_f32 v40, v31
    v_sin_f32 v41, v31
    s_nop 0
    v_mul_f32 v40, v40, v30
    v_mul_f32 v41, v41, v30
    v_mul_f32 v30, v8, v6
    v_mul_f32 v31, v9, v6
    v_fract_f32 v31, v31
    v_exp_f32 v30, v30
    v_cos_f32 v42, v31
    v_sin_f32 v43, v31
    s_nop 0
    v_mul_f32 v42, v42, v30
    v_mul_f32 v43, v43, v30
    v_mul_f32 v44, v42, v42
    v_fma_f32 v44, -v43, v43, v44
    v_mul_f32 v45, v42, v43
    v_add_f32 v45, v45, v45
    v_mul_f32 v46, v44, v44
    v_fma_f32 v46, -v45, v45, v46
    v_mul_f32 v47, v44, v45
    v_add_f32 v47, v47, v47
    v_mul_f32 v48, v10, v40
    v_fma_f32 v48, -v11, v41, v48
    v_mul_f32 v49, v10, v41
    v_fma_f32 v49, v11, v40, v49
    v_sub_f32 v50, 0, v33
    s_nop 1
    v_mfma_f32_16x16x4_f32 v[64:67], v48, v32, v[64:67]
    v_mfma_f32_16x16x4_f32 v[64:67], v49, v50, v[64:67]
    v_mul_f32 v48, v10, v42
    v_fma_f32 v48, -v11, v43, v48
    v_mul_f32 v49, v10, v43
    v_fma_f32 v49, v11, v42, v49
    v_sub_f32 v50, 0, v35
    s_nop 1
    v_mfma_f32_16x16x4_f32 v[68:71], v48, v34, v[68:71]
    v_mfma_f32_16x16x4_f32 v[68:71], v49, v50, v[68:71]
    v_mul_f32 v48, v10, v44
    v_fma_f32 v48, -v11, v45, v48
    v_mul_f32 v49, v10, v45
    v_fma_f32 v49, v11, v44, v49
    v_sub_f32 v50, 0, v37
    s_nop 1
    v_mfma_f32_16x16x4_f32 v[72:75], v48, v36, v[72:75]
    v_mfma_f32_16x16x4_f32 v[72:75], v49, v50, v[72:75]
    v_mul_f32 v48, v10, v46
    v_fma_f32 v48, -v11, v47, v48
    v_mul_f32 v49, v10, v47
    v_fma_f32 v49, v11, v46, v49
    v_sub_f32 v50, 0, v39
    s_nop 1
    v_mfma_f32_16x16x4_f32 v[76:79], v48, v38, v[76:79]
    v_mfma_f32_16x16x4_f32 v[76:79], v49, v50, v[76:79]
    s_waitcnt lgkmcnt(0)
    v_mov_b32 v8, v52
    v_mov_b32 v9, v53
    v_mov_b32 v10, v54
    v_mov_b32 v11, v55
    ds_read_b128 v[52:55], v7 offset:128
    v_mul_f32 v30, v8, v4
    v_mul_f32 v31, v9, v4
    v_fract_f32 v31, v31
    v_exp_f32 v30, v30
    v_cos_f32 v32, v31
    v_sin_f32 v33, v31
    s_nop 0
    v_mul_f32 v32, v32, v30
    v_mul_f32 v33, v33, v30
    v_mul_f32 v34, v32, v32
    v_fma_f32 v34, -v33, v33, v34
    v_mul_f32 v35, v32, v33
    v_add_f32 v35, v35, v35
    v_mul_f32 v36, v34, v34
    v_fma_f32 v36, -v35, v35, v36
    v_mul_f32 v37, v34, v35
    v_add_f32 v37, v37, v37
    v_mul_f32 v38, v36, v36
    v_fma_f32 v38, -v37, v37, v38
    v_mul_f32 v39, v36, v37
    v_add_f32 v39, v39, v39
    v_mul_f32 v30, v8, v5
    v_mul_f32 v31, v9, v5
    v_fract_f32 v31, v31
    v_exp_f32 v30, v30
    v_cos_f32 v40, v31
    v_sin_f32 v41, v31
    s_nop 0
    v_mul_f32 v40, v40, v30
    v_mul_f32 v41, v41, v30
    v_mul_f32 v30, v8, v6
    v_mul_f32 v31, v9, v6
    v_fract_f32 v31, v31
    v_exp_f32 v30, v30
    v_cos_f32 v42, v31
    v_sin_f32 v43, v31
    s_nop 0
    v_mul_f32 v42, v42, v30
    v_mul_f32 v43, v43, v30
    v_mul_f32 v44, v42, v42
    v_fma_f32 v44, -v43, v43, v44
    v_mul_f32 v45, v42, v43
    v_add_f32 v45, v45, v45
    v_mul_f32 v46, v44, v44
    v_fma_f32 v46, -v45, v45, v46
    v_mul_f32 v47, v44, v45
    v_add_f32 v47, v47, v47
    v_mul_f32 v48, v10, v40
    v_fma_f32 v48, -v11, v41, v48
    v_mul_f32 v49, v10, v41
    v_fma_f32 v49, v11, v40, v49
    v_sub_f32 v50, 0, v33
    s_nop 1
    v_mfma_f32_16x16x4_f32 v[64:67], v48, v32, v[64:67]
    v_mfma_f32_16x16x4_f32 v[64:67], v49, v50, v[64:67]
    v_mul_f32 v48, v10, v42
    v_fma_f32 v48, -v11, v43, v48
    v_mul_f32 v49, v10, v43
    v_fma_f32 v49, v11, v42, v49
    v_sub_f32 v50, 0, v35
    s_nop 1
    v_mfma_f32_16x16x4_f32 v[68:71], v48, v34, v[68:71]
    v_mfma_f32_16x16x4_f32 v[68:71], v49, v50, v[68:71]
    v_mul_f32 v48, v10, v44
    v_fma_f32 v48, -v11, v45, v48
    v_mul_f32 v49, v10, v45
    v_fma_f32 v49, v11, v44, v49
    v_sub_f32 v50, 0, v37
    s_nop 1
    v_mfma_f32_16x16x4_f32 v[72:75], v48, v36, v[72:75]
    v_mfma_f32_16x16x4_f32 v[72:75], v49, v50, v[72:75]
    v_mul_f32 v48, v10, v46
    v_fma_f32 v48, -v11, v47, v48
    v_mul_f32 v49, v10, v47
    v_fma_f32 v49, v11, v46, v49
    v_sub_f32 v50, 0, v39
    s_nop 1
    v_mfma_f32_16x16x4_f32 v[76:79], v48, v38, v[76:79]
    v_mfma_f32_16x16x4_f32 v[76:79], v49, v50, v[76:79]
    s_waitcnt lgkmcnt(0)
    v_mov_b32 v8, v52
    v_mov_b32 v9, v53
    v_mov_b32 v10, v54
    v_mov_b32 v11, v55
    ds_read_b128 v[52:55], v7 offset:192
    v_mul_f32 v30, v8, v4
    v_mul_f32 v31, v9, v4
    v_fract_f32 v31, v31
    v_exp_f32 v30, v30
    v_cos_f32 v32, v31
    v_sin_f32 v33, v31
    s_nop 0
    v_mul_f32 v32, v32, v30
    v_mul_f32 v33, v33, v30
    v_mul_f32 v34, v32, v32
    v_fma_f32 v34, -v33, v33, v34
    v_mul_f32 v35, v32, v33
    v_add_f32 v35, v35, v35
    v_mul_f32 v36, v34, v34
    v_fma_f32 v36, -v35, v35, v36
    v_mul_f32 v37, v34, v35
    v_add_f32 v37, v37, v37
    v_mul_f32 v38, v36, v36
    v_fma_f32 v38, -v37, v37, v38
    v_mul_f32 v39, v36, v37
    v_add_f32 v39, v39, v39
    v_mul_f32 v30, v8, v5
    v_mul_f32 v31, v9, v5
    v_fract_f32 v31, v31
    v_exp_f32 v30, v30
    v_cos_f32 v40, v31
    v_sin_f32 v41, v31
    s_nop 0
    v_mul_f32 v40, v40, v30
    v_mul_f32 v41, v41, v30
    v_mul_f32 v30, v8, v6
    v_mul_f32 v31, v9, v6
    v_fract_f32 v31, v31
    v_exp_f32 v30, v30
    v_cos_f32 v42, v31
    v_sin_f32 v43, v31
    s_nop 0
    v_mul_f32 v42, v42, v30
    v_mul_f32 v43, v43, v30
    v_mul_f32 v44, v42, v42
    v_fma_f32 v44, -v43, v43, v44
    v_mul_f32 v45, v42, v43
    v_add_f32 v45, v45, v45
    v_mul_f32 v46, v44, v44
    v_fma_f32 v46, -v45, v45, v46
    v_mul_f32 v47, v44, v45
    v_add_f32 v47, v47, v47
    v_mul_f32 v48, v10, v40
    v_fma_f32 v48, -v11, v41, v48
    v_mul_f32 v49, v10, v41
    v_fma_f32 v49, v11, v40, v49
    v_sub_f32 v50, 0, v33
    s_nop 1
    v_mfma_f32_16x16x4_f32 v[64:67], v48, v32, v[64:67]
    v_mfma_f32_16x16x4_f32 v[64:67], v49, v50, v[64:67]
    v_mul_f32 v48, v10, v42
    v_fma_f32 v48, -v11, v43, v48
    v_mul_f32 v49, v10, v43
    v_fma_f32 v49, v11, v42, v49
    v_sub_f32 v50, 0, v35
    s_nop 1
    v_mfma_f32_16x16x4_f32 v[68:71], v48, v34, v[68:71]
    v_mfma_f32_16x16x4_f32 v[68:71], v49, v50, v[68:71]
    v_mul_f32 v48, v10, v44
    v_fma_f32 v48, -v11, v45, v48
    v_mul_f32 v49, v10, v45
    v_fma_f32 v49, v11, v44, v49
    v_sub_f32 v50, 0, v37
    s_nop 1
    v_mfma_f32_16x16x4_f32 v[72:75], v48, v36, v[72:75]
    v_mfma_f32_16x16x4_f32 v[72:75], v49, v50, v[72:75]
    v_mul_f32 v48, v10, v46
    v_fma_f32 v48, -v11, v47, v48
    v_mul_f32 v49, v10, v47
    v_fma_f32 v49, v11, v46, v49
    v_sub_f32 v50, 0, v39
    s_nop 1
    v_mfma_f32_16x16x4_f32 v[76:79], v48, v38, v[76:79]
    v_mfma_f32_16x16x4_f32 v[76:79], v49, v50, v[76:79]
    s_waitcnt lgkmcnt(0)
    v_mov_b32 v8, v52
    v_mov_b32 v9, v53
    v_mov_b32 v10, v54
    v_mov_b32 v11, v55
    ds_read_b128 v[52:55], v7 offset:256
    v_mul_f32 v30, v8, v4
    v_mul_f32 v31, v9, v4
    v_fract_f32 v31, v31
    v_exp_f32 v30, v30
    v_cos_f32 v32, v31
    v_sin_f32 v33, v31
    s_nop 0
    v_mul_f32 v32, v32, v30
    v_mul_f32 v33, v33, v30
    v_mul_f32 v34, v32, v32
    v_fma_f32 v34, -v33, v33, v34
    v_mul_f32 v35, v32, v33
    v_add_f32 v35, v35, v35
    v_mul_f32 v36, v34, v34
    v_fma_f32 v36, -v35, v35, v36
    v_mul_f32 v37, v34, v35
    v_add_f32 v37, v37, v37
    v_mul_f32 v38, v36, v36
    v_fma_f32 v38, -v37, v37, v38
    v_mul_f32 v39, v36, v37
    v_add_f32 v39, v39, v39
    v_mul_f32 v30, v8, v5
    v_mul_f32 v31, v9, v5
    v_fract_f32 v31, v31
    v_exp_f32 v30, v30
    v_cos_f32 v40, v31
    v_sin_f32 v41, v31
    s_nop 0
    v_mul_f32 v40, v40, v30
    v_mul_f32 v41, v41, v30
    v_mul_f32 v30, v8, v6
    v_mul_f32 v31, v9, v6
    v_fract_f32 v31, v31
    v_exp_f32 v30, v30
    v_cos_f32 v42, v31
    v_sin_f32 v43, v31
    s_nop 0
    v_mul_f32 v42, v42, v30
    v_mul_f32 v43, v43, v30
    v_mul_f32 v44, v42, v42
    v_fma_f32 v44, -v43, v43, v44
    v_mul_f32 v45, v42, v43
    v_add_f32 v45, v45, v45
    v_mul_f32 v46, v44, v44
    v_fma_f32 v46, -v45, v45, v46
    v_mul_f32 v47, v44, v45
    v_add_f32 v47, v47, v47
    v_mul_f32 v48, v10, v40
    v_fma_f32 v48, -v11, v41, v48
    v_mul_f32 v49, v10, v41
    v_fma_f32 v49, v11, v40, v49
    v_sub_f32 v50, 0, v33
    s_nop 1
    v_mfma_f32_16x16x4_f32 v[64:67], v48, v32, v[64:67]
    v_mfma_f32_16x16x4_f32 v[64:67], v49, v50, v[64:67]
    v_mul_f32 v48, v10, v42
    v_fma_f32 v48, -v11, v43, v48
    v_mul_f32 v49, v10, v43
    v_fma_f32 v49, v11, v42, v49
    v_sub_f32 v50, 0, v35
    s_nop 1
    v_mfma_f32_16x16x4_f32 v[68:71], v48, v34, v[68:71]
    v_mfma_f32_16x16x4_f32 v[68:71], v49, v50, v[68:71]
    v_mul_f32 v48, v10, v44
    v_fma_f32 v48, -v11, v45, v48
    v_mul_f32 v49, v10, v45
    v_fma_f32 v49, v11, v44, v49
    v_sub_f32 v50, 0, v37
    s_nop 1
    v_mfma_f32_16x16x4_f32 v[72:75], v48, v36, v[72:75]
    v_mfma_f32_16x16x4_f32 v[72:75], v49, v50, v[72:75]
    v_mul_f32 v48, v10, v46
    v_fma_f32 v48, -v11, v47, v48
    v_mul_f32 v49, v10, v47
    v_fma_f32 v49, v11, v46, v49
    v_sub_f32 v50, 0, v39
    s_nop 1
    v_mfma_f32_16x16x4_f32 v[76:79], v48, v38, v[76:79]
    v_mfma_f32_16x16x4_f32 v[76:79], v49, v50, v[76:79]
    s_waitcnt lgkmcnt(0)
    v_mov_b32 v8, v52
    v_mov_b32 v9, v53
    v_mov_b32 v10, v54
    v_mov_b32 v11, v55
    ds_read_b128 v[52:55], v7 offset:320
    v_mul_f32 v30, v8, v4
    v_mul_f32 v31, v9, v4
    v_fract_f32 v31, v31
    v_exp_f32 v30, v30
    v_cos_f32 v32, v31
    v_sin_f32 v33, v31
    s_nop 0
    v_mul_f32 v32, v32, v30
    v_mul_f32 v33, v33, v30
    v_mul_f32 v34, v32, v32
    v_fma_f32 v34, -v33, v33, v34
    v_mul_f32 v35, v32, v33
    v_add_f32 v35, v35, v35
    v_mul_f32 v36, v34, v34
    v_fma_f32 v36, -v35, v35, v36
    v_mul_f32 v37, v34, v35
    v_add_f32 v37, v37, v37
    v_mul_f32 v38, v36, v36
    v_fma_f32 v38, -v37, v37, v38
    v_mul_f32 v39, v36, v37
    v_add_f32 v39, v39, v39
    v_mul_f32 v30, v8, v5
    v_mul_f32 v31, v9, v5
    v_fract_f32 v31, v31
    v_exp_f32 v30, v30
    v_cos_f32 v40, v31
    v_sin_f32 v41, v31
    s_nop 0
    v_mul_f32 v40, v40, v30
    v_mul_f32 v41, v41, v30
    v_mul_f32 v30, v8, v6
    v_mul_f32 v31, v9, v6
    v_fract_f32 v31, v31
    v_exp_f32 v30, v30
    v_cos_f32 v42, v31
    v_sin_f32 v43, v31
    s_nop 0
    v_mul_f32 v42, v42, v30
    v_mul_f32 v43, v43, v30
    v_mul_f32 v44, v42, v42
    v_fma_f32 v44, -v43, v43, v44
    v_mul_f32 v45, v42, v43
    v_add_f32 v45, v45, v45
    v_mul_f32 v46, v44, v44
    v_fma_f32 v46, -v45, v45, v46
    v_mul_f32 v47, v44, v45
    v_add_f32 v47, v47, v47
    v_mul_f32 v48, v10, v40
    v_fma_f32 v48, -v11, v41, v48
    v_mul_f32 v49, v10, v41
    v_fma_f32 v49, v11, v40, v49
    v_sub_f32 v50, 0, v33
    s_nop 1
    v_mfma_f32_16x16x4_f32 v[64:67], v48, v32, v[64:67]
    v_mfma_f32_16x16x4_f32 v[64:67], v49, v50, v[64:67]
    v_mul_f32 v48, v10, v42
    v_fma_f32 v48, -v11, v43, v48
    v_mul_f32 v49, v10, v43
    v_fma_f32 v49, v11, v42, v49
    v_sub_f32 v50, 0, v35
    s_nop 1
    v_mfma_f32_16x16x4_f32 v[68:71], v48, v34, v[68:71]
    v_mfma_f32_16x16x4_f32 v[68:71], v49, v50, v[68:71]
    v_mul_f32 v48, v10, v44
    v_fma_f32 v48, -v11, v45, v48
    v_mul_f32 v49, v10, v45
    v_fma_f32 v49, v11, v44, v49
    v_sub_f32 v50, 0, v37
    s_nop 1
    v_mfma_f32_16x16x4_f32 v[72:75], v48, v36, v[72:75]
    v_mfma_f32_16x16x4_f32 v[72:75], v49, v50, v[72:75]
    v_mul_f32 v48, v10, v46
    v_fma_f32 v48, -v11, v47, v48
    v_mul_f32 v49, v10, v47
    v_fma_f32 v49, v11, v46, v49
    v_sub_f32 v50, 0, v39
    s_nop 1
    v_mfma_f32_16x16x4_f32 v[76:79], v48, v38, v[76:79]
    v_mfma_f32_16x16x4_f32 v[76:79], v49, v50, v[76:79]
    s_waitcnt lgkmcnt(0)
    v_mov_b32 v8, v52
    v_mov_b32 v9, v53
    v_mov_b32 v10, v54
    v_mov_b32 v11, v55
    ds_read_b128 v[52:55], v7 offset:384
    v_mul_f32 v30, v8, v4
    v_mul_f32 v31, v9, v4
    v_fract_f32 v31, v31
    v_exp_f32 v30, v30
    v_cos_f32 v32, v31
    v_sin_f32 v33, v31
    s_nop 0
    v_mul_f32 v32, v32, v30
    v_mul_f32 v33, v33, v30
    v_mul_f32 v34, v32, v32
    v_fma_f32 v34, -v33, v33, v34
    v_mul_f32 v35, v32, v33
    v_add_f32 v35, v35, v35
    v_mul_f32 v36, v34, v34
    v_fma_f32 v36, -v35, v35, v36
    v_mul_f32 v37, v34, v35
    v_add_f32 v37, v37, v37
    v_mul_f32 v38, v36, v36
    v_fma_f32 v38, -v37, v37, v38
    v_mul_f32 v39, v36, v37
    v_add_f32 v39, v39, v39
    v_mul_f32 v30, v8, v5
    v_mul_f32 v31, v9, v5
    v_fract_f32 v31, v31
    v_exp_f32 v30, v30
    v_cos_f32 v40, v31
    v_sin_f32 v41, v31
    s_nop 0
    v_mul_f32 v40, v40, v30
    v_mul_f32 v41, v41, v30
    v_mul_f32 v30, v8, v6
    v_mul_f32 v31, v9, v6
    v_fract_f32 v31, v31
    v_exp_f32 v30, v30
    v_cos_f32 v42, v31
    v_sin_f32 v43, v31
    s_nop 0
    v_mul_f32 v42, v42, v30
    v_mul_f32 v43, v43, v30
    v_mul_f32 v44, v42, v42
    v_fma_f32 v44, -v43, v43, v44
    v_mul_f32 v45, v42, v43
    v_add_f32 v45, v45, v45
    v_mul_f32 v46, v44, v44
    v_fma_f32 v46, -v45, v45, v46
    v_mul_f32 v47, v44, v45
    v_add_f32 v47, v47, v47
    v_mul_f32 v48, v10, v40
    v_fma_f32 v48, -v11, v41, v48
    v_mul_f32 v49, v10, v41
    v_fma_f32 v49, v11, v40, v49
    v_sub_f32 v50, 0, v33
    s_nop 1
    v_mfma_f32_16x16x4_f32 v[64:67], v48, v32, v[64:67]
    v_mfma_f32_16x16x4_f32 v[64:67], v49, v50, v[64:67]
    v_mul_f32 v48, v10, v42
    v_fma_f32 v48, -v11, v43, v48
    v_mul_f32 v49, v10, v43
    v_fma_f32 v49, v11, v42, v49
    v_sub_f32 v50, 0, v35
    s_nop 1
    v_mfma_f32_16x16x4_f32 v[68:71], v48, v34, v[68:71]
    v_mfma_f32_16x16x4_f32 v[68:71], v49, v50, v[68:71]
    v_mul_f32 v48, v10, v44
    v_fma_f32 v48, -v11, v45, v48
    v_mul_f32 v49, v10, v45
    v_fma_f32 v49, v11, v44, v49
    v_sub_f32 v50, 0, v37
    s_nop 1
    v_mfma_f32_16x16x4_f32 v[72:75], v48, v36, v[72:75]
    v_mfma_f32_16x16x4_f32 v[72:75], v49, v50, v[72:75]
    v_mul_f32 v48, v10, v46
    v_fma_f32 v48, -v11, v47, v48
    v_mul_f32 v49, v10, v47
    v_fma_f32 v49, v11, v46, v49
    v_sub_f32 v50, 0, v39
    s_nop 1
    v_mfma_f32_16x16x4_f32 v[76:79], v48, v38, v[76:79]
    v_mfma_f32_16x16x4_f32 v[76:79], v49, v50, v[76:79]
    s_waitcnt lgkmcnt(0)
    v_mov_b32 v8, v52
    v_mov_b32 v9, v53
    v_mov_b32 v10, v54
    v_mov_b32 v11, v55
    ds_read_b128 v[52:55], v7 offset:448
    v_mul_f32 v30, v8, v4
    v_mul_f32 v31, v9, v4
    v_fract_f32 v31, v31
    v_exp_f32 v30, v30
    v_cos_f32 v32, v31
    v_sin_f32 v33, v31
    s_nop 0
    v_mul_f32 v32, v32, v30
    v_mul_f32 v33, v33, v30
    v_mul_f32 v34, v32, v32
    v_fma_f32 v34, -v33, v33, v34
    v_mul_f32 v35, v32, v33
    v_add_f32 v35, v35, v35
    v_mul_f32 v36, v34, v34
    v_fma_f32 v36, -v35, v35, v36
    v_mul_f32 v37, v34, v35
    v_add_f32 v37, v37, v37
    v_mul_f32 v38, v36, v36
    v_fma_f32 v38, -v37, v37, v38
    v_mul_f32 v39, v36, v37
    v_add_f32 v39, v39, v39
    v_mul_f32 v30, v8, v5
    v_mul_f32 v31, v9, v5
    v_fract_f32 v31, v31
    v_exp_f32 v30, v30
    v_cos_f32 v40, v31
    v_sin_f32 v41, v31
    s_nop 0
    v_mul_f32 v40, v40, v30
    v_mul_f32 v41, v41, v30
    v_mul_f32 v30, v8, v6
    v_mul_f32 v31, v9, v6
    v_fract_f32 v31, v31
    v_exp_f32 v30, v30
    v_cos_f32 v42, v31
    v_sin_f32 v43, v31
    s_nop 0
    v_mul_f32 v42, v42, v30
    v_mul_f32 v43, v43, v30
    v_mul_f32 v44, v42, v42
    v_fma_f32 v44, -v43, v43, v44
    v_mul_f32 v45, v42, v43
    v_add_f32 v45, v45, v45
    v_mul_f32 v46, v44, v44
    v_fma_f32 v46, -v45, v45, v46
    v_mul_f32 v47, v44, v45
    v_add_f32 v47, v47, v47
    v_mul_f32 v48, v10, v40
    v_fma_f32 v48, -v11, v41, v48
    v_mul_f32 v49, v10, v41
    v_fma_f32 v49, v11, v40, v49
    v_sub_f32 v50, 0, v33
    s_nop 1
    v_mfma_f32_16x16x4_f32 v[64:67], v48, v32, v[64:67]
    v_mfma_f32_16x16x4_f32 v[64:67], v49, v50, v[64:67]
    v_mul_f32 v48, v10, v42
    v_fma_f32 v48, -v11, v43, v48
    v_mul_f32 v49, v10, v43
    v_fma_f32 v49, v11, v42, v49
    v_sub_f32 v50, 0, v35
    s_nop 1
    v_mfma_f32_16x16x4_f32 v[68:71], v48, v34, v[68:71]
    v_mfma_f32_16x16x4_f32 v[68:71], v49, v50, v[68:71]
    v_mul_f32 v48, v10, v44
    v_fma_f32 v48, -v11, v45, v48
    v_mul_f32 v49, v10, v45
    v_fma_f32 v49, v11, v44, v49
    v_sub_f32 v50, 0, v37
    s_nop 1
    v_mfma_f32_16x16x4_f32 v[72:75], v48, v36, v[72:75]
    v_mfma_f32_16x16x4_f32 v[72:75], v49, v50, v[72:75]
    v_mul_f32 v48, v10, v46
    v_fma_f32 v48, -v11, v47, v48
    v_mul_f32 v49, v10, v47
    v_fma_f32 v49, v11, v46, v49
    v_sub_f32 v50, 0, v39
    s_nop 1
    v_mfma_f32_16x16x4_f32 v[76:79], v48, v38, v[76:79]
    v_mfma_f32_16x16x4_f32 v[76:79], v49, v50, v[76:79]
    s_waitcnt lgkmcnt(0)
    v_mov_b32 v8, v52
    v_mov_b32 v9, v53
    v_mov_b32 v10, v54
    v_mov_b32 v11, v55
    v_mul_f32 v30, v8, v4
    v_mul_f32 v31, v9, v4
    v_fract_f32 v31, v31
    v_exp_f32 v30, v30
    v_cos_f32 v32, v31
    v_sin_f32 v33, v31
    s_nop 0
    v_mul_f32 v32, v32, v30
    v_mul_f32 v33, v33, v30
    v_mul_f32 v34, v32, v32
    v_fma_f32 v34, -v33, v33, v34
    v_mul_f32 v35, v32, v33
    v_add_f32 v35, v35, v35
    v_mul_f32 v36, v34, v34
    v_fma_f32 v36, -v35, v35, v36
    v_mul_f32 v37, v34, v35
    v_add_f32 v37, v37, v37
    v_mul_f32 v38, v36, v36
    v_fma_f32 v38, -v37, v37, v38
    v_mul_f32 v39, v36, v37
    v_add_f32 v39, v39, v39
    v_mul_f32 v30, v8, v5
    v_mul_f32 v31, v9, v5
    v_fract_f32 v31, v31
    v_exp_f32 v30, v30
    v_cos_f32 v40, v31
    v_sin_f32 v41, v31
    s_nop 0
    v_mul_f32 v40, v40, v30
    v_mul_f32 v41, v41, v30
    v_mul_f32 v30, v8, v6
    v_mul_f32 v31, v9, v6
    v_fract_f32 v31, v31
    v_exp_f32 v30, v30
    v_cos_f32 v42, v31
    v_sin_f32 v43, v31
    s_nop 0
    v_mul_f32 v42, v42, v30
    v_mul_f32 v43, v43, v30
    v_mul_f32 v44, v42, v42
    v_fma_f32 v44, -v43, v43, v44
    v_mul_f32 v45, v42, v43
    v_add_f32 v45, v45, v45
    v_mul_f32 v46, v44, v44
    v_fma_f32 v46, -v45, v45, v46
    v_mul_f32 v47, v44, v45
    v_add_f32 v47, v47, v47
    v_mul_f32 v48, v10, v40
    v_fma_f32 v48, -v11, v41, v48
    v_mul_f32 v49, v10, v41
    v_fma_f32 v49, v11, v40, v49
    v_sub_f32 v50, 0, v33
    s_nop 1
    v_mfma_f32_16x16x4_f32 v[64:67], v48, v32, v[64:67]
    v_mfma_f32_16x16x4_f32 v[64:67], v49, v50, v[64:67]
    v_mul_f32 v48, v10, v42
    v_fma_f32 v48, -v11, v43, v48
    v_mul_f32 v49, v10, v43
    v_fma_f32 v49, v11, v42, v49
    v_sub_f32 v50, 0, v35
    s_nop 1
    v_mfma_f32_16x16x4_f32 v[68:71], v48, v34, v[68:71]
    v_mfma_f32_16x16x4_f32 v[68:71], v49, v50, v[68:71]
    v_mul_f32 v48, v10, v44
    v_fma_f32 v48, -v11, v45, v48
    v_mul_f32 v49, v10, v45
    v_fma_f32 v49, v11, v44, v49
    v_sub_f32 v50, 0, v37
    s_nop 1
    v_mfma_f32_16x16x4_f32 v[72:75], v48, v36, v[72:75]
    v_mfma_f32_16x16x4_f32 v[72:75], v49, v50, v[72:75]
    v_mul_f32 v48, v10, v46
    v_fma_f32 v48, -v11, v47, v48
    v_mul_f32 v49, v10, v47
    v_fma_f32 v49, v11, v46, v49
    v_sub_f32 v50, 0, v39
    s_nop 1
    v_mfma_f32_16x16x4_f32 v[76:79], v48, v38, v[76:79]
    v_mfma_f32_16x16x4_f32 v[76:79], v49, v50, v[76:79]
    s_nop 7
    s_nop 7
    v_lshlrev_b32 v7, 12, v1
    v_lshl_add_u32 v7, v3, 8, v7
    v_lshl_add_u32 v7, v2, 2, v7
    ds_write_b32 v7, v64 offset:2048
    ds_write_b32 v7, v65 offset:2112
    ds_write_b32 v7, v66 offset:2176
    ds_write_b32 v7, v67 offset:2240
    ds_write_b32 v7, v68 offset:3072
    ds_write_b32 v7, v69 offset:3136
    ds_write_b32 v7, v70 offset:3200
    ds_write_b32 v7, v71 offset:3264
    ds_write_b32 v7, v72 offset:4096
    ds_write_b32 v7, v73 offset:4160
    ds_write_b32 v7, v74 offset:4224
    ds_write_b32 v7, v75 offset:4288
    ds_write_b32 v7, v76 offset:5120
    ds_write_b32 v7, v77 offset:5184
    ds_write_b32 v7, v78 offset:5248
    ds_write_b32 v7, v79 offset:5312
    s_waitcnt lgkmcnt(0)
    s_barrier
    s_movk_i32 s27, 4160
    s_mul_i32 s27, s27, s24
    s_add_u32 s27, s27, 0x400000
    v_mov_b32 v1, v0
    v_lshlrev_b32 v2, 3, v1
    v_sub_u32 v2, 2048, v2
    v_or_b32 v3, 1, v2
    v_ffbh_u32 v3, v3
    v_sub_u32 v3, 24, v3
    v_max_i32 v3, 0, v3
    v_lshlrev_b32 v4, v3, 1
    v_lshrrev_b32 v4, 1, v4
    v_lshrrev_b32 v5, v3, v2
    v_and_b32 v5, 1, v5
    v_add3_u32 v4, v4, v5, -1
    v_max_i32 v4, 0, v4
    v_add_u32 v4, v4, v2
    v_lshrrev_b32 v4, v3, v4
    v_lshlrev_b32 v5, 8, v3
    v_subrev_u32 v5, 128, v5
    v_max_i32 v5, 0, v5
    v_add_u32 v4, v4, v5
    v_min_u32 v4, 0x3ff, v4
    v_lshlrev_b32 v4, 2, v4
    ds_read_b32 v60, v4 offset:2048
    ds_read_b32 v61, v4 offset:6144
    ds_read_b32 v62, v4 offset:10240
    ds_read_b32 v63, v4 offset:14336
    v_mov_b32 v40, v2
    v_lshlrev_b32 v2, 3, v1
    v_sub_u32 v2, 2047, v2
    v_or_b32 v3, 1, v2
    v_ffbh_u32 v3, v3
    v_sub_u32 v3, 24, v3
    v_max_i32 v3, 0, v3
    v_lshlrev_b32 v4, v3, 1
    v_lshrrev_b32 v4, 1, v4
    v_lshrrev_b32 v5, v3, v2
    v_and_b32 v5, 1, v5
    v_add3_u32 v4, v4, v5, -1
    v_max_i32 v4, 0, v4
    v_add_u32 v4, v4, v2
    v_lshrrev_b32 v4, v3, v4
    v_lshlrev_b32 v5, 8, v3
    v_subrev_u32 v5, 128, v5
    v_max_i32 v5, 0, v5
    v_add_u32 v4, v4, v5
    v_min_u32 v4, 0x3ff, v4
    v_lshlrev_b32 v4, 2, v4
    ds_read_b32 v64, v4 offset:2048
    ds_read_b32 v65, v4 offset:6144
    ds_read_b32 v66, v4 offset:10240
    ds_read_b32 v67, v4 offset:14336
    v_mov_b32 v41, v2
    v_lshlrev_b32 v2, 3, v1
    v_sub_u32 v2, 2046, v2
    v_or_b32 v3, 1, v2
    v_ffbh_u32 v3, v3
    v_sub_u32 v3, 24, v3
    v_max_i32 v3, 0, v3
    v_lshlrev_b32 v4, v3, 1
    v_lshrrev_b32 v4, 1, v4
    v_lshrrev_b32 v5, v3, v2
    v_and_b32 v5, 1, v5
    v_add3_u32 v4, v4, v5, -1
    v_max_i32 v4, 0, v4
    v_add_u32 v4, v4, v2
    v_lshrrev_b32 v4, v3, v4
    v_lshlrev_b32 v5, 8, v3
    v_subrev_u32 v5, 128, v5
    v_max_i32 v5, 0, v5
    v_add_u32 v4, v4, v5
    v_min_u32 v4, 0x3ff, v4
    v_lshlrev_b32 v4, 2, v4
    ds_read_b32 v68, v4 offset:2048
    ds_read_b32 v69, v4 offset:6144
    ds_read_b32 v70, v4 offset:10240
    ds_read_b32 v71, v4 offset:14336
    v_mov_b32 v42, v2
    v_lshlrev_b32 v2, 3, v1
    v_sub_u32 v2, 2045, v2
    v_or_b32 v3, 1, v2
    v_ffbh_u32 v3, v3
    v_sub_u32 v3, 24, v3
    v_max_i32 v3, 0, v3
    v_lshlrev_b32 v4, v3, 1
    v_lshrrev_b32 v4, 1, v4
    v_lshrrev_b32 v5, v3, v2
    v_and_b32 v5, 1, v5
    v_add3_u32 v4, v4, v5, -1
    v_max_i32 v4, 0, v4
    v_add_u32 v4, v4, v2
    v_lshrrev_b32 v4, v3, v4
    v_lshlrev_b32 v5, 8, v3
    v_subrev_u32 v5, 128, v5
    v_max_i32 v5, 0, v5
    v_add_u32 v4, v4, v5
    v_min_u32 v4, 0x3ff, v4
    v_lshlrev_b32 v4, 2, v4
    ds_read_b32 v72, v4 offset:2048
    ds_read_b32 v73, v4 offset:6144
    ds_read_b32 v74, v4 offset:10240
    ds_read_b32 v75, v4 offset:14336
    v_mov_b32 v43, v2
    v_lshlrev_b32 v2, 3, v1
    v_sub_u32 v2, 2044, v2
    v_or_b32 v3, 1, v2
    v_ffbh_u32 v3, v3
    v_sub_u32 v3, 24, v3
    v_max_i32 v3, 0, v3
    v_lshlrev_b32 v4, v3, 1
    v_lshrrev_b32 v4, 1, v4
    v_lshrrev_b32 v5, v3, v2
    v_and_b32 v5, 1, v5
    v_add3_u32 v4, v4, v5, -1
    v_max_i32 v4, 0, v4
    v_add_u32 v4, v4, v2
    v_lshrrev_b32 v4, v3, v4
    v_lshlrev_b32 v5, 8, v3
    v_subrev_u32 v5, 128, v5
    v_max_i32 v5, 0, v5
    v_add_u32 v4, v4, v5
    v_min_u32 v4, 0x3ff, v4
    v_lshlrev_b32 v4, 2, v4
    ds_read_b32 v76, v4 offset:2048
    ds_read_b32 v77, v4 offset:6144
    ds_read_b32 v78, v4 offset:10240
    ds_read_b32 v79, v4 offset:14336
    v_mov_b32 v44, v2
    v_lshlrev_b32 v2, 3, v1
    v_sub_u32 v2, 2043, v2
    v_or_b32 v3, 1, v2
    v_ffbh_u32 v3, v3
    v_sub_u32 v3, 24, v3
    v_max_i32 v3, 0, v3
    v_lshlrev_b32 v4, v3, 1
    v_lshrrev_b32 v4, 1, v4
    v_lshrrev_b32 v5, v3, v2
    v_and_b32 v5, 1, v5
    v_add3_u32 v4, v4, v5, -1
    v_max_i32 v4, 0, v4
    v_add_u32 v4, v4, v2
    v_lshrrev_b32 v4, v3, v4
    v_lshlrev_b32 v5, 8, v3
    v_subrev_u32 v5, 128, v5
    v_max_i32 v5, 0, v5
    v_add_u32 v4, v4, v5
    v_min_u32 v4, 0x3ff, v4
    v_lshlrev_b32 v4, 2, v4
    ds_read_b32 v80, v4 offset:2048
    ds_read_b32 v81, v4 offset:6144
    ds_read_b32 v82, v4 offset:10240
    ds_read_b32 v83, v4 offset:14336
    v_mov_b32 v45, v2
    v_lshlrev_b32 v2, 3, v1
    v_sub_u32 v2, 2042, v2
    v_or_b32 v3, 1, v2
    v_ffbh_u32 v3, v3
    v_sub_u32 v3, 24, v3
    v_max_i32 v3, 0, v3
    v_lshlrev_b32 v4, v3, 1
    v_lshrrev_b32 v4, 1, v4
    v_lshrrev_b32 v5, v3, v2
    v_and_b32 v5, 1, v5
    v_add3_u32 v4, v4, v5, -1
    v_max_i32 v4, 0, v4
    v_add_u32 v4, v4, v2
    v_lshrrev_b32 v4, v3, v4
    v_lshlrev_b32 v5, 8, v3
    v_subrev_u32 v5, 128, v5
    v_max_i32 v5, 0, v5
    v_add_u32 v4, v4, v5
    v_min_u32 v4, 0x3ff, v4
    v_lshlrev_b32 v4, 2, v4
    ds_read_b32 v84, v4 offset:2048
    ds_read_b32 v85, v4 offset:6144
    ds_read_b32 v86, v4 offset:10240
    ds_read_b32 v87, v4 offset:14336
    v_mov_b32 v46, v2
    v_lshlrev_b32 v2, 3, v1
    v_sub_u32 v2, 2041, v2
    v_or_b32 v3, 1, v2
    v_ffbh_u32 v3, v3
    v_sub_u32 v3, 24, v3
    v_max_i32 v3, 0, v3
    v_lshlrev_b32 v4, v3, 1
    v_lshrrev_b32 v4, 1, v4
    v_lshrrev_b32 v5, v3, v2
    v_and_b32 v5, 1, v5
    v_add3_u32 v4, v4, v5, -1
    v_max_i32 v4, 0, v4
    v_add_u32 v4, v4, v2
    v_lshrrev_b32 v4, v3, v4
    v_lshlrev_b32 v5, 8, v3
    v_subrev_u32 v5, 128, v5
    v_max_i32 v5, 0, v5
    v_add_u32 v4, v4, v5
    v_min_u32 v4, 0x3ff, v4
    v_lshlrev_b32 v4, 2, v4
    ds_read_b32 v88, v4 offset:2048
    ds_read_b32 v89, v4 offset:6144
    ds_read_b32 v90, v4 offset:10240
    ds_read_b32 v91, v4 offset:14336
    v_mov_b32 v47, v2
    s_waitcnt lgkmcnt(0)
    v_add_f32 v20, v60, v61
    v_add_f32 v22, v62, v63
    v_add_f32 v20, v20, v22
    v_cmp_gt_u32 vcc, 0x800, v40
    s_nop 1
    v_cndmask_b32 v8, 0, v20, vcc
    v_add_f32 v20, v64, v65
    v_add_f32 v22, v66, v67
    v_add_f32 v20, v20, v22
    v_cmp_gt_u32 vcc, 0x800, v41
    s_nop 1
    v_cndmask_b32 v9, 0, v20, vcc
    v_add_f32 v20, v68, v69
    v_add_f32 v22, v70, v71
    v_add_f32 v20, v20, v22
    v_cmp_gt_u32 vcc, 0x800, v42
    s_nop 1
    v_cndmask_b32 v10, 0, v20, vcc
    v_add_f32 v20, v72, v73
    v_add_f32 v22, v74, v75
    v_add_f32 v20, v20, v22
    v_cmp_gt_u32 vcc, 0x800, v43
    s_nop 1
    v_cndmask_b32 v11, 0, v20, vcc
    v_add_f32 v20, v76, v77
    v_add_f32 v22, v78, v79
    v_add_f32 v20, v20, v22
    v_cmp_gt_u32 vcc, 0x800, v44
    s_nop 1
    v_cndmask_b32 v12, 0, v20, vcc
    v_add_f32 v20, v80, v81
    v_add_f32 v22, v82, v83
    v_add_f32 v20, v20, v22
    v_cmp_gt_u32 vcc, 0x800, v45
    s_nop 1
    v_cndmask_b32 v13, 0, v20, vcc
    v_add_f32 v20, v84, v85
    v_add_f32 v22, v86, v87
    v_add_f32 v20, v20, v22
    v_cmp_gt_u32 vcc, 0x800, v46
    s_nop 1
    v_cndmask_b32 v14, 0, v20, vcc
    v_add_f32 v20, v88, v89
    v_add_f32 v22, v90, v91
    v_add_f32 v20, v20, v22
    v_cmp_gt_u32 vcc, 0x800, v47
    s_nop 1
    v_cndmask_b32 v15, 0, v20, vcc
    v_cvt_pk_bf16_f32 v24, v8, v9
    v_cvt_pk_bf16_f32 v25, v10, v11
    v_cvt_pk_bf16_f32 v26, v12, v13
    v_cvt_pk_bf16_f32 v27, v14, v15
    v_lshlrev_b32 v2, 4, v1
    v_add_u32 v2, s27, v2
    buffer_store_dwordx4 v[24:27], v2, s[12:15], 0 offen
    s_nop 1
    v_add_u32 v1, 256, v0
    v_min_u32 v1, 0x103, v1
    v_lshlrev_b32 v2, 3, v1
    v_sub_u32 v2, 2048, v2
    v_or_b32 v3, 1, v2
    v_ffbh_u32 v3, v3
    v_sub_u32 v3, 24, v3
    v_max_i32 v3, 0, v3
    v_lshlrev_b32 v4, v3, 1
    v_lshrrev_b32 v4, 1, v4
    v_lshrrev_b32 v5, v3, v2
    v_and_b32 v5, 1, v5
    v_add3_u32 v4, v4, v5, -1
    v_max_i32 v4, 0, v4
    v_add_u32 v4, v4, v2
    v_lshrrev_b32 v4, v3, v4
    v_lshlrev_b32 v5, 8, v3
    v_subrev_u32 v5, 128, v5
    v_max_i32 v5, 0, v5
    v_add_u32 v4, v4, v5
    v_min_u32 v4, 0x3ff, v4
    v_lshlrev_b32 v4, 2, v4
    ds_read_b32 v60, v4 offset:2048
    ds_read_b32 v61, v4 offset:6144
    ds_read_b32 v62, v4 offset:10240
    ds_read_b32 v63, v4 offset:14336
    v_mov_b32 v40, v2
    v_lshlrev_b32 v2, 3, v1
    v_sub_u32 v2, 2047, v2
    v_or_b32 v3, 1, v2
    v_ffbh_u32 v3, v3
    v_sub_u32 v3, 24, v3
    v_max_i32 v3, 0, v3
    v_lshlrev_b32 v4, v3, 1
    v_lshrrev_b32 v4, 1, v4
    v_lshrrev_b32 v5, v3, v2
    v_and_b32 v5, 1, v5
    v_add3_u32 v4, v4, v5, -1
    v_max_i32 v4, 0, v4
    v_add_u32 v4, v4, v2
    v_lshrrev_b32 v4, v3, v4
    v_lshlrev_b32 v5, 8, v3
    v_subrev_u32 v5, 128, v5
    v_max_i32 v5, 0, v5
    v_add_u32 v4, v4, v5
    v_min_u32 v4, 0x3ff, v4
    v_lshlrev_b32 v4, 2, v4
    ds_read_b32 v64, v4 offset:2048
    ds_read_b32 v65, v4 offset:6144
    ds_read_b32 v66, v4 offset:10240
    ds_read_b32 v67, v4 offset:14336
    v_mov_b32 v41, v2
    v_lshlrev_b32 v2, 3, v1
    v_sub_u32 v2, 2046, v2
    v_or_b32 v3, 1, v2
    v_ffbh_u32 v3, v3
    v_sub_u32 v3, 24, v3
    v_max_i32 v3, 0, v3
    v_lshlrev_b32 v4, v3, 1
    v_lshrrev_b32 v4, 1, v4
    v_lshrrev_b32 v5, v3, v2
    v_and_b32 v5, 1, v5
    v_add3_u32 v4, v4, v5, -1
    v_max_i32 v4, 0, v4
    v_add_u32 v4, v4, v2
    v_lshrrev_b32 v4, v3, v4
    v_lshlrev_b32 v5, 8, v3
    v_subrev_u32 v5, 128, v5
    v_max_i32 v5, 0, v5
    v_add_u32 v4, v4, v5
    v_min_u32 v4, 0x3ff, v4
    v_lshlrev_b32 v4, 2, v4
    ds_read_b32 v68, v4 offset:2048
    ds_read_b32 v69, v4 offset:6144
    ds_read_b32 v70, v4 offset:10240
    ds_read_b32 v71, v4 offset:14336
    v_mov_b32 v42, v2
    v_lshlrev_b32 v2, 3, v1
    v_sub_u32 v2, 2045, v2
    v_or_b32 v3, 1, v2
    v_ffbh_u32 v3, v3
    v_sub_u32 v3, 24, v3
    v_max_i32 v3, 0, v3
    v_lshlrev_b32 v4, v3, 1
    v_lshrrev_b32 v4, 1, v4
    v_lshrrev_b32 v5, v3, v2
    v_and_b32 v5, 1, v5
    v_add3_u32 v4, v4, v5, -1
    v_max_i32 v4, 0, v4
    v_add_u32 v4, v4, v2
    v_lshrrev_b32 v4, v3, v4
    v_lshlrev_b32 v5, 8, v3
    v_subrev_u32 v5, 128, v5
    v_max_i32 v5, 0, v5
    v_add_u32 v4, v4, v5
    v_min_u32 v4, 0x3ff, v4
    v_lshlrev_b32 v4, 2, v4
    ds_read_b32 v72, v4 offset:2048
    ds_read_b32 v73, v4 offset:6144
    ds_read_b32 v74, v4 offset:10240
    ds_read_b32 v75, v4 offset:14336
    v_mov_b32 v43, v2
    v_lshlrev_b32 v2, 3, v1
    v_sub_u32 v2, 2044, v2
    v_or_b32 v3, 1, v2
    v_ffbh_u32 v3, v3
    v_sub_u32 v3, 24, v3
    v_max_i32 v3, 0, v3
    v_lshlrev_b32 v4, v3, 1
    v_lshrrev_b32 v4, 1, v4
    v_lshrrev_b32 v5, v3, v2
    v_and_b32 v5, 1, v5
    v_add3_u32 v4, v4, v5, -1
    v_max_i32 v4, 0, v4
    v_add_u32 v4, v4, v2
    v_lshrrev_b32 v4, v3, v4
    v_lshlrev_b32 v5, 8, v3
    v_subrev_u32 v5, 128, v5
    v_max_i32 v5, 0, v5
    v_add_u32 v4, v4, v5
    v_min_u32 v4, 0x3ff, v4
    v_lshlrev_b32 v4, 2, v4
    ds_read_b32 v76, v4 offset:2048
    ds_read_b32 v77, v4 offset:6144
    ds_read_b32 v78, v4 offset:10240
    ds_read_b32 v79, v4 offset:14336
    v_mov_b32 v44, v2
    v_lshlrev_b32 v2, 3, v1
    v_sub_u32 v2, 2043, v2
    v_or_b32 v3, 1, v2
    v_ffbh_u32 v3, v3
    v_sub_u32 v3, 24, v3
    v_max_i32 v3, 0, v3
    v_lshlrev_b32 v4, v3, 1
    v_lshrrev_b32 v4, 1, v4
    v_lshrrev_b32 v5, v3, v2
    v_and_b32 v5, 1, v5
    v_add3_u32 v4, v4, v5, -1
    v_max_i32 v4, 0, v4
    v_add_u32 v4, v4, v2
    v_lshrrev_b32 v4, v3, v4
    v_lshlrev_b32 v5, 8, v3
    v_subrev_u32 v5, 128, v5
    v_max_i32 v5, 0, v5
    v_add_u32 v4, v4, v5
    v_min_u32 v4, 0x3ff, v4
    v_lshlrev_b32 v4, 2, v4
    ds_read_b32 v80, v4 offset:2048
    ds_read_b32 v81, v4 offset:6144
    ds_read_b32 v82, v4 offset:10240
    ds_read_b32 v83, v4 offset:14336
    v_mov_b32 v45, v2
    v_lshlrev_b32 v2, 3, v1
    v_sub_u32 v2, 2042, v2
    v_or_b32 v3, 1, v2
    v_ffbh_u32 v3, v3
    v_sub_u32 v3, 24, v3
    v_max_i32 v3, 0, v3
    v_lshlrev_b32 v4, v3, 1
    v_lshrrev_b32 v4, 1, v4
    v_lshrrev_b32 v5, v3, v2
    v_and_b32 v5, 1, v5
    v_add3_u32 v4, v4, v5, -1
    v_max_i32 v4, 0, v4
    v_add_u32 v4, v4, v2
    v_lshrrev_b32 v4, v3, v4
    v_lshlrev_b32 v5, 8, v3
    v_subrev_u32 v5, 128, v5
    v_max_i32 v5, 0, v5
    v_add_u32 v4, v4, v5
    v_min_u32 v4, 0x3ff, v4
    v_lshlrev_b32 v4, 2, v4
    ds_read_b32 v84, v4 offset:2048
    ds_read_b32 v85, v4 offset:6144
    ds_read_b32 v86, v4 offset:10240
    ds_read_b32 v87, v4 offset:14336
    v_mov_b32 v46, v2
    v_lshlrev_b32 v2, 3, v1
    v_sub_u32 v2, 2041, v2
    v_or_b32 v3, 1, v2
    v_ffbh_u32 v3, v3
    v_sub_u32 v3, 24, v3
    v_max_i32 v3, 0, v3
    v_lshlrev_b32 v4, v3, 1
    v_lshrrev_b32 v4, 1, v4
    v_lshrrev_b32 v5, v3, v2
    v_and_b32 v5, 1, v5
    v_add3_u32 v4, v4, v5, -1
    v_max_i32 v4, 0, v4
    v_add_u32 v4, v4, v2
    v_lshrrev_b32 v4, v3, v4
    v_lshlrev_b32 v5, 8, v3
    v_subrev_u32 v5, 128, v5
    v_max_i32 v5, 0, v5
    v_add_u32 v4, v4, v5
    v_min_u32 v4, 0x3ff, v4
    v_lshlrev_b32 v4, 2, v4
    ds_read_b32 v88, v4 offset:2048
    ds_read_b32 v89, v4 offset:6144
    ds_read_b32 v90, v4 offset:10240
    ds_read_b32 v91, v4 offset:14336
    v_mov_b32 v47, v2
    s_waitcnt lgkmcnt(0)
    v_add_f32 v20, v60, v61
    v_add_f32 v22, v62, v63
    v_add_f32 v20, v20, v22
    v_cmp_gt_u32 vcc, 0x800, v40
    s_nop 1
    v_cndmask_b32 v8, 0, v20, vcc
    v_add_f32 v20, v64, v65
    v_add_f32 v22, v66, v67
    v_add_f32 v20, v20, v22
    v_cmp_gt_u32 vcc, 0x800, v41
    s_nop 1
    v_cndmask_b32 v9, 0, v20, vcc
    v_add_f32 v20, v68, v69
    v_add_f32 v22, v70, v71
    v_add_f32 v20, v20, v22
    v_cmp_gt_u32 vcc, 0x800, v42
    s_nop 1
    v_cndmask_b32 v10, 0, v20, vcc
    v_add_f32 v20, v72, v73
    v_add_f32 v22, v74, v75
    v_add_f32 v20, v20, v22
    v_cmp_gt_u32 vcc, 0x800, v43
    s_nop 1
    v_cndmask_b32 v11, 0, v20, vcc
    v_add_f32 v20, v76, v77
    v_add_f32 v22, v78, v79
    v_add_f32 v20, v20, v22
    v_cmp_gt_u32 vcc, 0x800, v44
    s_nop 1
    v_cndmask_b32 v12, 0, v20, vcc
    v_add_f32 v20, v80, v81
    v_add_f32 v22, v82, v83
    v_add_f32 v20, v20, v22
    v_cmp_gt_u32 vcc, 0x800, v45
    s_nop 1
    v_cndmask_b32 v13, 0, v20, vcc
    v_add_f32 v20, v84, v85
    v_add_f32 v22, v86, v87
    v_add_f32 v20, v20, v22
    v_cmp_gt_u32 vcc, 0x800, v46
    s_nop 1
    v_cndmask_b32 v14, 0, v20, vcc
    v_add_f32 v20, v88, v89
    v_add_f32 v22, v90, v91
    v_add_f32 v20, v20, v22
    v_cmp_gt_u32 vcc, 0x800, v47
    s_nop 1
    v_cndmask_b32 v15, 0, v20, vcc
    v_cvt_pk_bf16_f32 v24, v8, v9
    v_cvt_pk_bf16_f32 v25, v10, v11
    v_cvt_pk_bf16_f32 v26, v12, v13
    v_cvt_pk_bf16_f32 v27, v14, v15
    v_lshlrev_b32 v2, 4, v1
    v_add_u32 v2, s27, v2
    buffer_store_dwordx4 v[24:27], v2, s[12:15], 0 offen
    s_nop 1
    s_waitcnt vmcnt(0)
    s_endpgm
k1_tr_2:
    s_sub_u32 s24, s24, 512
    s_cmp_ge_u32 s24, 224
    s_cbranch_scc1 tr_w2_4
    s_load_dwordx2 s[4:5], s[0:1], 80
    s_mov_b32 s28, 1792
    s_mov_b32 s29, 512
    s_mul_hi_u32 s30, s24, 0x924924A
    s_mul_i32 s31, s30, 28
    s_sub_u32 s31, s24, s31
    s_mov_b32 s32, 0x620000
    s_branch tr_j_5
tr_w2_4:
    s_load_dwordx2 s[4:5], s[0:1], 96
    s_mov_b32 s28, 512
    s_mov_b32 s29, 1792
    s_sub_u32 s33, s24, 224
    s_lshr_b32 s30, s33, 3
    s_and_b32 s31, s33, 7
    s_mov_b32 s32, 0x7e0000
tr_j_5:
    s_waitcnt lgkmcnt(0)
    s_mov_b32 s16, s4
    s_mov_b32 s17, s5
    s_mov_b32 s18, 1835008
    s_mov_b32 s19, 0x00020000
    v_lshrrev_b32 v1, 2, v0
    v_and_b32 v2, 3, v0
    s_lshl_b32 s33, s30, 6
    v_add_u32 v3, s33, v1
    v_mul_lo_u32 v3, v3, s28
    s_lshl_b32 s34, s31, 6
    v_add_u32 v3, s34, v3
    v_lshlrev_b32 v3, 1, v3
    v_lshl_add_u32 v3, v2, 5, v3
    buffer_load_dwordx4 v[8:11], v3, s[16:19], 0 offen
    buffer_load_dwordx4 v[12:15], v3, s[16:19], 0 offen offset:16
    s_movk_i32 s35, 144
    v_mul_lo_u32 v4, v1, s35
    v_lshl_add_u32 v4, v2, 5, v4
    s_waitcnt vmcnt(0)
    ds_write_b128 v4, v[8:11]
    ds_write_b128 v4, v[12:15] offset:16
    s_waitcnt lgkmcnt(0)
    s_barrier
    v_lshlrev_b32 v5, 1, v1
    s_movk_i32 s35, 2304
    v_mul_lo_u32 v6, v2, s35
    v_add_u32 v5, v5, v6
    ds_read_u16 v8, v5 offset:0
    ds_read_u16 v16, v5 offset:144
    ds_read_u16 v9, v5 offset:288
    ds_read_u16 v17, v5 offset:432
    ds_read_u16 v10, v5 offset:576
    ds_read_u16 v18, v5 offset:720
    ds_read_u16 v11, v5 offset:864
    ds_read_u16 v19, v5 offset:1008
    ds_read_u16 v12, v5 offset:1152
    ds_read_u16 v20, v5 offset:1296
    ds_read_u16 v13, v5 offset:1440
    ds_read_u16 v21, v5 offset:1584
    ds_read_u16 v14, v5 offset:1728
    ds_read_u16 v22, v5 offset:1872
    ds_read_u16 v15, v5 offset:2016
    ds_read_u16 v23, v5 offset:2160
    v_add_u32 v3, s34, v1
    v_mul_lo_u32 v3, v3, s29
    v_add_u32 v3, s33, v3
    v_lshlrev_b32 v3, 1, v3
    v_lshl_add_u32 v3, v2, 5, v3
    v_add_u32 v3, s32, v3
    s_waitcnt lgkmcnt(0)
    v_lshl_or_b32 v8, v16, 16, v8
    v_lshl_or_b32 v9, v17, 16, v9
    v_lshl_or_b32 v10, v18, 16, v10
    v_lshl_or_b32 v11, v19, 16, v11
    v_lshl_or_b32 v12, v20, 16, v12
    v_lshl_or_b32 v13, v21, 16, v13
    v_lshl_or_b32 v14, v22, 16, v14
    v_lshl_or_b32 v15, v23, 16, v15
    buffer_store_dwordx4 v[8:11], v3, s[12:15], 0 offen
    buffer_store_dwordx4 v[12:15], v3, s[12:15], 0 offen offset:16
    s_waitcnt vmcnt(0)
k1_end_3:
    s_endpgm
.globl k2_kernel
.p2align 8
.type k2_kernel,@function
k2_kernel:
    s_cmp_ge_u32 s2, 736
    s_cbranch_scc1 end_6
    s_load_dwordx2 s[6:7], s[0:1], 128
    s_waitcnt lgkmcnt(0)
    s_mov_b32 s12, s6
    s_mov_b32 s13, s7
    s_mov_b32 s14, 268435456
    s_mov_b32 s15, 0x00020000
    s_cmp_ge_u32 s2, 224
    s_cbranch_scc1 conv_7
    s_lshr_b32 s44, s2, 4
    s_lshl_b32 s44, s44, 7
    s_and_b32 s45, s2, 15
    s_lshl_b32 s45, s45, 7
    v_lshrrev_b32 v1, 6, v0
    v_and_b32 v2, 63, v0
    v_readfirstlane_b32 s40, v1
    v_lshrrev_b32 v3, 3, v2
    v_lshl_add_u32 v3, v1, 3, v3
    v_lshrrev_b32 v4, 1, v3
    v_and_b32 v4, 7, v4
    v_and_b32 v5, 7, v2
    v_xor_b32 v4, v4, v5
    v_lshlrev_b32 v4, 4, v4
    v_add_u32 v5, s44, v3
    s_mov_b32 s41, 1024
    v_mul_lo_u32 v5, v5, s41
    v_add_u32 v5, v5, v4
    v_add_u32 v6, s45, v3
    s_mov_b32 s41, 1024
    v_mul_lo_u32 v6, v6, s41
    v_add_u32 v6, v6, v4
    v_and_b32 v7, 31, v2
    v_lshrrev_b32 v8, 5, v2
    v_lshrrev_b32 v9, 1, v7
    v_and_b32 v9, 7, v9
    v_and_b32 v10, 1, v1
    v_bfe_u32 v11, v1, 1, 1
    s_lshr_b32 s46, s40, 2
    v_add_u32 v12, 0, v8
    v_xor_b32 v12, v12, v9
    v_lshlrev_b32 v12, 4, v12
    v_lshl_add_u32 v12, v7, 7, v12
    v_mul_u32_u24 v13, 8192, v10
    v_add_u32 v16, v12, v13
    v_mul_u32_u24 v13, 8192, v11
    v_add_u32 v13, 16384, v13
    v_add_u32 v20, v12, v13
    v_add_u32 v12, 2, v8
    v_xor_b32 v12, v12, v9
    v_lshlrev_b32 v12, 4, v12
    v_lshl_add_u32 v12, v7, 7, v12
    v_mul_u32_u24 v13, 8192, v10
    v_add_u32 v17, v12, v13
    v_mul_u32_u24 v13, 8192, v11
    v_add_u32 v13, 16384, v13
    v_add_u32 v21, v12, v13
    v_add_u32 v12, 4, v8
    v_xor_b32 v12, v12, v9
    v_lshlrev_b32 v12, 4, v12
    v_lshl_add_u32 v12, v7, 7, v12
    v_mul_u32_u24 v13, 8192, v10
    v_add_u32 v18, v12, v13
    v_mul_u32_u24 v13, 8192, v11
    v_add_u32 v13, 16384, v13
    v_add_u32 v22, v12, v13
    v_add_u32 v12, 6, v8
    v_xor_b32 v12, v12, v9
    v_lshlrev_b32 v12, 4, v12
    v_lshl_add_u32 v12, v7, 7, v12
    v_mul_u32_u24 v13, 8192, v10
    v_add_u32 v19, v12, v13
    v_mul_u32_u24 v13, 8192, v11
    v_add_u32 v13, 16384, v13
    v_add_u32 v23, v12, v13
    v_mov_b32 v64, 0
    v_mov_b32 v65, 0
    v_mov_b32 v66, 0
    v_mov_b32 v67, 0
    v_mov_b32 v68, 0
    v_mov_b32 v69, 0
    v_mov_b32 v70, 0
    v_mov_b32 v71, 0
    v_mov_b32 v72, 0
    v_mov_b32 v73, 0
    v_mov_b32 v74, 0
    v_mov_b32 v75, 0
    v_mov_b32 v76, 0
    v_mov_b32 v77, 0
    v_mov_b32 v78, 0
    v_mov_b32 v79, 0
    v_mov_b32 v80, 0
    v_mov_b32 v81, 0
    v_mov_b32 v82, 0
    v_mov_b32 v83, 0
    v_mov_b32 v84, 0
    v_mov_b32 v85, 0
    v_mov_b32 v86, 0
    v_mov_b32 v87, 0
    v_mov_b32 v88, 0
    v_mov_b32 v89, 0
    v_mov_b32 v90, 0
    v_mov_b32 v91, 0
    v_mov_b32 v92, 0
    v_mov_b32 v93, 0
    v_mov_b32 v94, 0
    v_mov_b32 v95, 0
    v_mov_b32 v96, 0
    v_mov_b32 v97, 0
    v_mov_b32 v98, 0
    v_mov_b32 v99, 0
    v_mov_b32 v100, 0
    v_mov_b32 v101, 0
    v_mov_b32 v102, 0
    v_mov_b32 v103, 0
    v_mov_b32 v104, 0
    v_mov_b32 v105, 0
    v_mov_b32 v106, 0
    v_mov_b32 v107, 0
    v_mov_b32 v108, 0
    v_mov_b32 v109, 0
    v_mov_b32 v110, 0
    v_mov_b32 v111, 0
    v_mov_b32 v112, 0
    v_mov_b32 v113, 0
    v_mov_b32 v114, 0
    v_mov_b32 v115, 0
    v_mov_b32 v116, 0
    v_mov_b32 v117, 0
    v_mov_b32 v118, 0
    v_mov_b32 v119, 0
    v_mov_b32 v120, 0
    v_mov_b32 v121, 0
    v_mov_b32 v122, 0
    v_mov_b32 v123, 0
    v_mov_b32 v124, 0
    v_mov_b32 v125, 0
    v_mov_b32 v126, 0
    v_mov_b32 v127, 0
    s_load_dwordx2 s[4:5], s[0:1], 88
    s_waitcnt lgkmcnt(0)
    s_mov_b32 s16, s4
    s_mov_b32 s17, s5
    s_mov_b32 s18, 3584
    s_mov_b32 s19, 0x00020000
    v_lshlrev_b32 v12, 6, v10
    v_lshl_add_u32 v12, v8, 2, v12
    v_add_u32 v12, s44, v12
    v_lshlrev_b32 v13, 1, v12
    buffer_load_dwordx2 v[128:129], v13, s[16:19], 0 offen offset:0
    buffer_load_dwordx2 v[130:131], v13, s[16:19], 0 offen offset:16
    buffer_load_dwordx2 v[132:133], v13, s[16:19], 0 offen offset:32
    buffer_load_dwordx2 v[134:135], v13, s[16:19], 0 offen offset:48
    buffer_load_dwordx2 v[136:137], v13, s[16:19], 0 offen offset:64
    buffer_load_dwordx2 v[138:139], v13, s[16:19], 0 offen offset:80
    buffer_load_dwordx2 v[140:141], v13, s[16:19], 0 offen offset:96
    buffer_load_dwordx2 v[142:143], v13, s[16:19], 0 offen offset:112
    s_lshl_b32 s42, s40, 10
    s_add_u32 s42, s42, 0
    s_mov_b32 m0, s42
    s_mov_b32 s43, 6422528
    buffer_load_dwordx4 v5, s[12:15], s43 offen lds
    s_lshl_b32 s42, s40, 10
    s_add_u32 s42, s42, 4096
    s_mov_b32 m0, s42
    s_mov_b32 s43, 6455296
    buffer_load_dwordx4 v5, s[12:15], s43 offen lds
    s_lshl_b32 s42, s40, 10
    s_add_u32 s42, s42, 8192
    s_mov_b32 m0, s42
    s_mov_b32 s43, 6488064
    buffer_load_dwordx4 v5, s[12:15], s43 offen lds
    s_lshl_b32 s42, s40, 10
    s_add_u32 s42, s42, 12288
    s_mov_b32 m0, s42
    s_mov_b32 s43, 6520832
    buffer_load_dwordx4 v5, s[12:15], s43 offen lds
    s_lshl_b32 s42, s40, 10
    s_add_u32 s42, s42, 16384
    s_mov_b32 m0, s42
    s_mov_b32 s43, 2097152
    buffer_load_dwordx4 v6, s[12:15], s43 offen lds
    s_lshl_b32 s42, s40, 10
    s_add_u32 s42, s42, 20480
    s_mov_b32 m0, s42
    s_mov_b32 s43, 2129920
    buffer_load_dwordx4 v6, s[12:15], s43 offen lds
    s_lshl_b32 s42, s40, 10
    s_add_u32 s42, s42, 24576
    s_mov_b32 m0, s42
    s_mov_b32 s43, 2162688
    buffer_load_dwordx4 v6, s[12:15], s43 offen lds
    s_lshl_b32 s42, s40, 10
    s_add_u32 s42, s42, 28672
    s_mov_b32 m0, s42
    s_mov_b32 s43, 2195456
    buffer_load_dwordx4 v6, s[12:15], s43 offen lds
    s_waitcnt vmcnt(0)
    s_barrier
    s_lshl_b32 s42, s40, 10
    s_add_u32 s42, s42, 32768
    s_mov_b32 m0, s42
    s_mov_b32 s43, 6422656
    buffer_load_dwordx4 v5, s[12:15], s43 offen lds
    s_lshl_b32 s42, s40, 10
    s_add_u32 s42, s42, 36864
    s_mov_b32 m0, s42
    s_mov_b32 s43, 6455424
    buffer_load_dwordx4 v5, s[12:15], s43 offen lds
    s_lshl_b32 s42, s40, 10
    s_add_u32 s42, s42, 40960
    s_mov_b32 m0, s42
    s_mov_b32 s43, 6488192
    buffer_load_dwordx4 v5, s[12:15], s43 offen lds
    s_lshl_b32 s42, s40, 10
    s_add_u32 s42, s42, 45056
    s_mov_b32 m0, s42
    s_mov_b32 s43, 6520960
    buffer_load_dwordx4 v5, s[12:15], s43 offen lds
    s_lshl_b32 s42, s40, 10
    s_add_u32 s42, s42, 49152
    s_mov_b32 m0, s42
    s_mov_b32 s43, 2097280
    buffer_load_dwordx4 v6, s[12:15], s43 offen lds
    s_lshl_b32 s42, s40, 10
    s_add_u32 s42, s42, 53248
    s_mov_b32 m0, s42
    s_mov_b32 s43, 2130048
    buffer_load_dwordx4 v6, s[12:15], s43 offen lds
    s_lshl_b32 s42, s40, 10
    s_add_u32 s42, s42, 57344
    s_mov_b32 m0, s42
    s_mov_b32 s43, 2162816
    buffer_load_dwordx4 v6, s[12:15], s43 offen lds
    s_lshl_b32 s42, s40, 10
    s_add_u32 s42, s42, 61440
    s_mov_b32 m0, s42
    s_mov_b32 s43, 2195584
    buffer_load_dwordx4 v6, s[12:15], s43 offen lds
    v_add_u32 v24, 0, v16
    v_add_u32 v25, 0, v17
    v_add_u32 v26, 0, v18
    v_add_u32 v27, 0, v19
    v_add_u32 v28, 0, v20
    v_add_u32 v29, 0, v21
    v_add_u32 v30, 0, v22
    v_add_u32 v31, 0, v23
    ds_read_b128 v[32:35], v24 offset:0
    ds_read_b128 v[36:39], v24 offset:4096
    ds_read_b128 v[48:51], v28 offset:0
    ds_read_b128 v[52:55], v28 offset:4096
    ds_read_b128 v[40:43], v25 offset:0
    ds_read_b128 v[44:47], v25 offset:4096
    ds_read_b128 v[56:59], v29 offset:0
    ds_read_b128 v[60:63], v29 offset:4096
    s_waitcnt lgkmcnt(4)
    v_mfma_f32_32x32x16_bf16 v[64:79], v[32:35], v[48:51], v[64:79]
    v_mfma_f32_32x32x16_bf16 v[80:95], v[32:35], v[52:55], v[80:95]
    v_mfma_f32_32x32x16_bf16 v[96:111], v[36:39], v[48:51], v[96:111]
    v_mfma_f32_32x32x16_bf16 v[112:127], v[36:39], v[52:55], v[112:127]
    ds_read_b128 v[32:35], v26 offset:0
    ds_read_b128 v[36:39], v26 offset:4096
    ds_read_b128 v[48:51], v30 offset:0
    ds_read_b128 v[52:55], v30 offset:4096
    s_waitcnt lgkmcnt(4)
    v_mfma_f32_32x32x16_bf16 v[64:79], v[40:43], v[56:59], v[64:79]
    v_mfma_f32_32x32x16_bf16 v[80:95], v[40:43], v[60:63], v[80:95]
    v_mfma_f32_32x32x16_bf16 v[96:111], v[44:47], v[56:59], v[96:111]
    v_mfma_f32_32x32x16_bf16 v[112:127], v[44:47], v[60:63], v[112:127]
    ds_read_b128 v[40:43], v27 offset:0
    ds_read_b128 v[44:47], v27 offset:4096
    ds_read_b128 v[56:59], v31 offset:0
    ds_read_b128 v[60:63], v31 offset:4096
    s_waitcnt lgkmcnt(4)
    v_mfma_f32_32x32x16_bf16 v[64:79], v[32:35], v[48:51], v[64:79]
    v_mfma_f32_32x32x16_bf16 v[80:95], v[32:35], v[52:55], v[80:95]
    v_mfma_f32_32x32x16_bf16 v[96:111], v[36:39], v[48:51], v[96:111]
    v_mfma_f32_32x32x16_bf16 v[112:127], v[36:39], v[52:55], v[112:127]
    s_waitcnt lgkmcnt(0)
    v_mfma_f32_32x32x16_bf16 v[64:79], v[40:43], v[56:59], v[64:79]
    v_mfma_f32_32x32x16_bf16 v[80:95], v[40:43], v[60:63], v[80:95]
    v_mfma_f32_32x32x16_bf16 v[96:111], v[44:47], v[56:59], v[96:111]
    v_mfma_f32_32x32x16_bf16 v[112:127], v[44:47], v[60:63], v[112:127]
    s_waitcnt vmcnt(0)
    s_barrier
    s_lshl_b32 s42, s40, 10
    s_add_u32 s42, s42, 0
    s_mov_b32 m0, s42
    s_mov_b32 s43, 6422784
    buffer_load_dwordx4 v5, s[12:15], s43 offen lds
    s_lshl_b32 s42, s40, 10
    s_add_u32 s42, s42, 4096
    s_mov_b32 m0, s42
    s_mov_b32 s43, 6455552
    buffer_load_dwordx4 v5, s[12:15], s43 offen lds
    s_lshl_b32 s42, s40, 10
    s_add_u32 s42, s42, 8192
    s_mov_b32 m0, s42
    s_mov_b32 s43, 6488320
    buffer_load_dwordx4 v5, s[12:15], s43 offen lds
    s_lshl_b32 s42, s40, 10
    s_add_u32 s42, s42, 12288
    s_mov_b32 m0, s42
    s_mov_b32 s43, 6521088
    buffer_load_dwordx4 v5, s[12:15], s43 offen lds
    s_lshl_b32 s42, s40, 10
    s_add_u32 s42, s42, 16384
    s_mov_b32 m0, s42
    s_mov_b32 s43, 2097408
    buffer_load_dwordx4 v6, s[12:15], s43 offen lds
    s_lshl_b32 s42, s40, 10
    s_add_u32 s42, s42, 20480
    s_mov_b32 m0, s42
    s_mov_b32 s43, 2130176
    buffer_load_dwordx4 v6, s[12:15], s43 offen lds
    s_lshl_b32 s42, s40, 10
    s_add_u32 s42, s42, 24576
    s_mov_b32 m0, s42
    s_mov_b32 s43, 2162944
    buffer_load_dwordx4 v6, s[12:15], s43 offen lds
    s_lshl_b32 s42, s40, 10
    s_add_u32 s42, s42, 28672
    s_mov_b32 m0, s42
    s_mov_b32 s43, 2195712
    buffer_load_dwordx4 v6, s[12:15], s43 offen lds
    v_add_u32 v24, 32768, v16
    v_add_u32 v25, 32768, v17
    v_add_u32 v26, 32768, v18
    v_add_u32 v27, 32768, v19
    v_add_u32 v28, 32768, v20
    v_add_u32 v29, 32768, v21
    v_add_u32 v30, 32768, v22
    v_add_u32 v31, 32768, v23
    ds_read_b128 v[32:35], v24 offset:0
    ds_read_b128 v[36:39], v24 offset:4096
    ds_read_b128 v[48:51], v28 offset:0
    ds_read_b128 v[52:55], v28 offset:4096
    ds_read_b128 v[40:43], v25 offset:0
    ds_read_b128 v[44:47], v25 offset:4096
    ds_read_b128 v[56:59], v29 offset:0
    ds_read_b128 v[60:63], v29 offset:4096
    s_waitcnt lgkmcnt(4)
    v_mfma_f32_32x32x16_bf16 v[64:79], v[32:35], v[48:51], v[64:79]
    v_mfma_f32_32x32x16_bf16 v[80:95], v[32:35], v[52:55], v[80:95]
    v_mfma_f32_32x32x16_bf16 v[96:111], v[36:39], v[48:51], v[96:111]
    v_mfma_f32_32x32x16_bf16 v[112:127], v[36:39], v[52:55], v[112:127]
    ds_read_b128 v[32:35], v26 offset:0
    ds_read_b128 v[36:39], v26 offset:4096
    ds_read_b128 v[48:51], v30 offset:0
    ds_read_b128 v[52:55], v30 offset:4096
    s_waitcnt lgkmcnt(4)
    v_mfma_f32_32x32x16_bf16 v[64:79], v[40:43], v[56:59], v[64:79]
    v_mfma_f32_32x32x16_bf16 v[80:95], v[40:43], v[60:63], v[80:95]
    v_mfma_f32_32x32x16_bf16 v[96:111], v[44:47], v[56:59], v[96:111]
    v_mfma_f32_32x32x16_bf16 v[112:127], v[44:47], v[60:63], v[112:127]
    ds_read_b128 v[40:43], v27 offset:0
    ds_read_b128 v[44:47], v27 offset:4096
    ds_read_b128 v[56:59], v31 offset:0
    ds_read_b128 v[60:63], v31 offset:4096
    s_waitcnt lgkmcnt(4)
    v_mfma_f32_32x32x16_bf16 v[64:79], v[32:35], v[48:51], v[64:79]
    v_mfma_f32_32x32x16_bf16 v[80:95], v[32:35], v[52:55], v[80:95]
    v_mfma_f32_32x32x16_bf16 v[96:111], v[36:39], v[48:51], v[96:111]
    v_mfma_f32_32x32x16_bf16 v[112:127], v[36:39], v[52:55], v[112:127]
    s_waitcnt lgkmcnt(0)
    v_mfma_f32_32x32x16_bf16 v[64:79], v[40:43], v[56:59], v[64:79]
    v_mfma_f32_32x32x16_bf16 v[80:95], v[40:43], v[60:63], v[80:95]
    v_mfma_f32_32x32x16_bf16 v[96:111], v[44:47], v[56:59], v[96:111]
    v_mfma_f32_32x32x16_bf16 v[112:127], v[44:47], v[60:63], v[112:127]
    s_waitcnt vmcnt(0)
    s_barrier
    s_lshl_b32 s42, s40, 10
    s_add_u32 s42, s42, 32768
    s_mov_b32 m0, s42
    s_mov_b32 s43, 6422912
    buffer_load_dwordx4 v5, s[12:15], s43 offen lds
    s_lshl_b32 s42, s40, 10
    s_add_u32 s42, s42, 36864
    s_mov_b32 m0, s42
    s_mov_b32 s43, 6455680
    buffer_load_dwordx4 v5, s[12:15], s43 offen lds
    s_lshl_b32 s42, s40, 10
    s_add_u32 s42, s42, 40960
    s_mov_b32 m0, s42
    s_mov_b32 s43, 6488448
    buffer_load_dwordx4 v5, s[12:15], s43 offen lds
    s_lshl_b32 s42, s40, 10
    s_add_u32 s42, s42, 45056
    s_mov_b32 m0, s42
    s_mov_b32 s43, 6521216
    buffer_load_dwordx4 v5, s[12:15], s43 offen lds
    s_lshl_b32 s42, s40, 10
    s_add_u32 s42, s42, 49152
    s_mov_b32 m0, s42
    s_mov_b32 s43, 2097536
    buffer_load_dwordx4 v6, s[12:15], s43 offen lds
    s_lshl_b32 s42, s40, 10
    s_add_u32 s42, s42, 53248
    s_mov_b32 m0, s42
    s_mov_b32 s43, 2130304
    buffer_load_dwordx4 v6, s[12:15], s43 offen lds
    s_lshl_b32 s42, s40, 10
    s_add_u32 s42, s42, 57344
    s_mov_b32 m0, s42
    s_mov_b32 s43, 2163072
    buffer_load_dwordx4 v6, s[12:15], s43 offen lds
    s_lshl_b32 s42, s40, 10
    s_add_u32 s42, s42, 61440
    s_mov_b32 m0, s42
    s_mov_b32 s43, 2195840
    buffer_load_dwordx4 v6, s[12:15], s43 offen lds
    v_add_u32 v24, 0, v16
    v_add_u32 v25, 0, v17
    v_add_u32 v26, 0, v18
    v_add_u32 v27, 0, v19
    v_add_u32 v28, 0, v20
    v_add_u32 v29, 0, v21
    v_add_u32 v30, 0, v22
    v_add_u32 v31, 0, v23
    ds_read_b128 v[32:35], v24 offset:0
    ds_read_b128 v[36:39], v24 offset:4096
    ds_read_b128 v[48:51], v28 offset:0
    ds_read_b128 v[52:55], v28 offset:4096
    ds_read_b128 v[40:43], v25 offset:0
    ds_read_b128 v[44:47], v25 offset:4096
    ds_read_b128 v[56:59], v29 offset:0
    ds_read_b128 v[60:63], v29 offset:4096
    s_waitcnt lgkmcnt(4)
    v_mfma_f32_32x32x16_bf16 v[64:79], v[32:35], v[48:51], v[64:79]
    v_mfma_f32_32x32x16_bf16 v[80:95], v[32:35], v[52:55], v[80:95]
    v_mfma_f32_32x32x16_bf16 v[96:111], v[36:39], v[48:51], v[96:111]
    v_mfma_f32_32x32x16_bf16 v[112:127], v[36:39], v[52:55], v[112:127]
    ds_read_b128 v[32:35], v26 offset:0
    ds_read_b128 v[36:39], v26 offset:4096
    ds_read_b128 v[48:51], v30 offset:0
    ds_read_b128 v[52:55], v30 offset:4096
    s_waitcnt lgkmcnt(4)
    v_mfma_f32_32x32x16_bf16 v[64:79], v[40:43], v[56:59], v[64:79]
    v_mfma_f32_32x32x16_bf16 v[80:95], v[40:43], v[60:63], v[80:95]
    v_mfma_f32_32x32x16_bf16 v[96:111], v[44:47], v[56:59], v[96:111]
    v_mfma_f32_32x32x16_bf16 v[112:127], v[44:47], v[60:63], v[112:127]
    ds_read_b128 v[40:43], v27 offset:0
    ds_read_b128 v[44:47], v27 offset:4096
    ds_read_b128 v[56:59], v31 offset:0
    ds_read_b128 v[60:63], v31 offset:4096
    s_waitcnt lgkmcnt(4)
    v_mfma_f32_32x32x16_bf16 v[64:79], v[32:35], v[48:51], v[64:79]
    v_mfma_f32_32x32x16_bf16 v[80:95], v[32:35], v[52:55], v[80:95]
    v_mfma_f32_32x32x16_bf16 v[96:111], v[36:39], v[48:51], v[96:111]
    v_mfma_f32_32x32x16_bf16 v[112:127], v[36:39], v[52:55], v[112:127]
    s_waitcnt lgkmcnt(0)
    v_mfma_f32_32x32x16_bf16 v[64:79], v[40:43], v[56:59], v[64:79]
    v_mfma_f32_32x32x16_bf16 v[80:95], v[40:43], v[60:63], v[80:95]
    v_mfma_f32_32x32x16_bf16 v[96:111], v[44:47], v[56:59], v[96:111]
    v_mfma_f32_32x32x16_bf16 v[112:127], v[44:47], v[60:63], v[112:127]
    s_waitcnt vmcnt(0)
    s_barrier
    s_lshl_b32 s42, s40, 10
    s_add_u32 s42, s42, 0
    s_mov_b32 m0, s42
    s_mov_b32 s43, 6423040
    buffer_load_dwordx4 v5, s[12:15], s43 offen lds
    s_lshl_b32 s42, s40, 10
    s_add_u32 s42, s42, 4096
    s_mov_b32 m0, s42
    s_mov_b32 s43, 6455808
    buffer_load_dwordx4 v5, s[12:15], s43 offen lds
    s_lshl_b32 s42, s40, 10
    s_add_u32 s42, s42, 8192
    s_mov_b32 m0, s42
    s_mov_b32 s43, 6488576
    buffer_load_dwordx4 v5, s[12:15], s43 offen lds
    s_lshl_b32 s42, s40, 10
    s_add_u32 s42, s42, 12288
    s_mov_b32 m0, s42
    s_mov_b32 s43, 6521344
    buffer_load_dwordx4 v5, s[12:15], s43 offen lds
    s_lshl_b32 s42, s40, 10
    s_add_u32 s42, s42, 16384
    s_mov_b32 m0, s42
    s_mov_b32 s43, 2097664
    buffer_load_dwordx4 v6, s[12:15], s43 offen lds
    s_lshl_b32 s42, s40, 10
    s_add_u32 s42, s42, 20480
    s_mov_b32 m0, s42
    s_mov_b32 s43, 2130432
    buffer_load_dwordx4 v6, s[12:15], s43 offen lds
    s_lshl_b32 s42, s40, 10
    s_add_u32 s42, s42, 24576
    s_mov_b32 m0, s42
    s_mov_b32 s43, 2163200
    buffer_load_dwordx4 v6, s[12:15], s43 offen lds
    s_lshl_b32 s42, s40, 10
    s_add_u32 s42, s42, 28672
    s_mov_b32 m0, s42
    s_mov_b32 s43, 2195968
    buffer_load_dwordx4 v6, s[12:15], s43 offen lds
    v_add_u32 v24, 32768, v16
    v_add_u32 v25, 32768, v17
    v_add_u32 v26, 32768, v18
    v_add_u32 v27, 32768, v19
    v_add_u32 v28, 32768, v20
    v_add_u32 v29, 32768, v21
    v_add_u32 v30, 32768, v22
    v_add_u32 v31, 32768, v23
    ds_read_b128 v[32:35], v24 offset:0
    ds_read_b128 v[36:39], v24 offset:4096
    ds_read_b128 v[48:51], v28 offset:0
    ds_read_b128 v[52:55], v28 offset:4096
    ds_read_b128 v[40:43], v25 offset:0
    ds_read_b128 v[44:47], v25 offset:4096
    ds_read_b128 v[56:59], v29 offset:0
    ds_read_b128 v[60:63], v29 offset:4096
    s_waitcnt lgkmcnt(4)
    v_mfma_f32_32x32x16_bf16 v[64:79], v[32:35], v[48:51], v[64:79]
    v_mfma_f32_32x32x16_bf16 v[80:95], v[32:35], v[52:55], v[80:95]
    v_mfma_f32_32x32x16_bf16 v[96:111], v[36:39], v[48:51], v[96:111]
    v_mfma_f32_32x32x16_bf16 v[112:127], v[36:39], v[52:55], v[112:127]
    ds_read_b128 v[32:35], v26 offset:0
    ds_read_b128 v[36:39], v26 offset:4096
    ds_read_b128 v[48:51], v30 offset:0
    ds_read_b128 v[52:55], v30 offset:4096
    s_waitcnt lgkmcnt(4)
    v_mfma_f32_32x32x16_bf16 v[64:79], v[40:43], v[56:59], v[64:79]
    v_mfma_f32_32x32x16_bf16 v[80:95], v[40:43], v[60:63], v[80:95]
    v_mfma_f32_32x32x16_bf16 v[96:111], v[44:47], v[56:59], v[96:111]
    v_mfma_f32_32x32x16_bf16 v[112:127], v[44:47], v[60:63], v[112:127]
    ds_read_b128 v[40:43], v27 offset:0
    ds_read_b128 v[44:47], v27 offset:4096
    ds_read_b128 v[56:59], v31 offset:0
    ds_read_b128 v[60:63], v31 offset:4096
    s_waitcnt lgkmcnt(4)
    v_mfma_f32_32x32x16_bf16 v[64:79], v[32:35], v[48:51], v[64:79]
    v_mfma_f32_32x32x16_bf16 v[80:95], v[32:35], v[52:55], v[80:95]
    v_mfma_f32_32x32x16_bf16 v[96:111], v[36:39], v[48:51], v[96:111]
    v_mfma_f32_32x32x16_bf16 v[112:127], v[36:39], v[52:55], v[112:127]
    s_waitcnt lgkmcnt(0)
    v_mfma_f32_32x32x16_bf16 v[64:79], v[40:43], v[56:59], v[64:79]
    v_mfma_f32_32x32x16_bf16 v[80:95], v[40:43], v[60:63], v[80:95]
    v_mfma_f32_32x32x16_bf16 v[96:111], v[44:47], v[56:59], v[96:111]
    v_mfma_f32_32x32x16_bf16 v[112:127], v[44:47], v[60:63], v[112:127]
    s_waitcnt vmcnt(0)
    s_barrier
    s_lshl_b32 s42, s40, 10
    s_add_u32 s42, s42, 32768
    s_mov_b32 m0, s42
    s_mov_b32 s43, 6423168
    buffer_load_dwordx4 v5, s[12:15], s43 offen lds
    s_lshl_b32 s42, s40, 10
    s_add_u32 s42, s42, 36864
    s_mov_b32 m0, s42
    s_mov_b32 s43, 6455936
    buffer_load_dwordx4 v5, s[12:15], s43 offen lds
    s_lshl_b32 s42, s40, 10
    s_add_u32 s42, s42, 40960
    s_mov_b32 m0, s42
    s_mov_b32 s43, 6488704
    buffer_load_dwordx4 v5, s[12:15], s43 offen lds
    s_lshl_b32 s42, s40, 10
    s_add_u32 s42, s42, 45056
    s_mov_b32 m0, s42
    s_mov_b32 s43, 6521472
    buffer_load_dwordx4 v5, s[12:15], s43 offen lds
    s_lshl_b32 s42, s40, 10
    s_add_u32 s42, s42, 49152
    s_mov_b32 m0, s42
    s_mov_b32 s43, 2097792
    buffer_load_dwordx4 v6, s[12:15], s43 offen lds
    s_lshl_b32 s42, s40, 10
    s_add_u32 s42, s42, 53248
    s_mov_b32 m0, s42
    s_mov_b32 s43, 2130560
    buffer_load_dwordx4 v6, s[12:15], s43 offen lds
    s_lshl_b32 s42, s40, 10
    s_add_u32 s42, s42, 57344
    s_mov_b32 m0, s42
    s_mov_b32 s43, 2163328
    buffer_load_dwordx4 v6, s[12:15], s43 offen lds
    s_lshl_b32 s42, s40, 10
    s_add_u32 s42, s42, 61440
    s_mov_b32 m0, s42
    s_mov_b32 s43, 2196096
    buffer_load_dwordx4 v6, s[12:15], s43 offen lds
    v_add_u32 v24, 0, v16
    v_add_u32 v25, 0, v17
    v_add_u32 v26, 0, v18
    v_add_u32 v27, 0, v19
    v_add_u32 v28, 0, v20
    v_add_u32 v29, 0, v21
    v_add_u32 v30, 0, v22
    v_add_u32 v31, 0, v23
    ds_read_b128 v[32:35], v24 offset:0
    ds_read_b128 v[36:39], v24 offset:4096
    ds_read_b128 v[48:51], v28 offset:0
    ds_read_b128 v[52:55], v28 offset:4096
    ds_read_b128 v[40:43], v25 offset:0
    ds_read_b128 v[44:47], v25 offset:4096
    ds_read_b128 v[56:59], v29 offset:0
    ds_read_b128 v[60:63], v29 offset:4096
    s_waitcnt lgkmcnt(4)
    v_mfma_f32_32x32x16_bf16 v[64:79], v[32:35], v[48:51], v[64:79]
    v_mfma_f32_32x32x16_bf16 v[80:95], v[32:35], v[52:55], v[80:95]
    v_mfma_f32_32x32x16_bf16 v[96:111], v[36:39], v[48:51], v[96:111]
    v_mfma_f32_32x32x16_bf16 v[112:127], v[36:39], v[52:55], v[112:127]
    ds_read_b128 v[32:35], v26 offset:0
    ds_read_b128 v[36:39], v26 offset:4096
    ds_read_b128 v[48:51], v30 offset:0
    ds_read_b128 v[52:55], v30 offset:4096
    s_waitcnt lgkmcnt(4)
    v_mfma_f32_32x32x16_bf16 v[64:79], v[40:43], v[56:59], v[64:79]
    v_mfma_f32_32x32x16_bf16 v[80:95], v[40:43], v[60:63], v[80:95]
    v_mfma_f32_32x32x16_bf16 v[96:111], v[44:47], v[56:59], v[96:111]
    v_mfma_f32_32x32x16_bf16 v[112:127], v[44:47], v[60:63], v[112:127]
    ds_read_b128 v[40:43], v27 offset:0
    ds_read_b128 v[44:47], v27 offset:4096
    ds_read_b128 v[56:59], v31 offset:0
    ds_read_b128 v[60:63], v31 offset:4096
    s_waitcnt lgkmcnt(4)
    v_mfma_f32_32x32x16_bf16 v[64:79], v[32:35], v[48:51], v[64:79]
    v_mfma_f32_32x32x16_bf16 v[80:95], v[32:35], v[52:55], v[80:95]
    v_mfma_f32_32x32x16_bf16 v[96:111], v[36:39], v[48:51], v[96:111]
    v_mfma_f32_32x32x16_bf16 v[112:127], v[36:39], v[52:55], v[112:127]
    s_waitcnt lgkmcnt(0)
    v_mfma_f32_32x32x16_bf16 v[64:79], v[40:43], v[56:59], v[64:79]
    v_mfma_f32_32x32x16_bf16 v[80:95], v[40:43], v[60:63], v[80:95]
    v_mfma_f32_32x32x16_bf16 v[96:111], v[44:47], v[56:59], v[96:111]
    v_mfma_f32_32x32x16_bf16 v[112:127], v[44:47], v[60:63], v[112:127]
    s_waitcnt vmcnt(0)
    s_barrier
    s_lshl_b32 s42, s40, 10
    s_add_u32 s42, s42, 0
    s_mov_b32 m0, s42
    s_mov_b32 s43, 6423296
    buffer_load_dwordx4 v5, s[12:15], s43 offen lds
    s_lshl_b32 s42, s40, 10
    s_add_u32 s42, s42, 4096
    s_mov_b32 m0, s42
    s_mov_b32 s43, 6456064
    buffer_load_dwordx4 v5, s[12:15], s43 offen lds
    s_lshl_b32 s42, s40, 10
    s_add_u32 s42, s42, 8192
    s_mov_b32 m0, s42
    s_mov_b32 s43, 6488832
    buffer_load_dwordx4 v5, s[12:15], s43 offen lds
    s_lshl_b32 s42, s40, 10
    s_add_u32 s42, s42, 12288
    s_mov_b32 m0, s42
    s_mov_b32 s43, 6521600
    buffer_load_dwordx4 v5, s[12:15], s43 offen lds
    s_lshl_b32 s42, s40, 10
    s_add_u32 s42, s42, 16384
    s_mov_b32 m0, s42
    s_mov_b32 s43, 2097920
    buffer_load_dwordx4 v6, s[12:15], s43 offen lds
    s_lshl_b32 s42, s40, 10
    s_add_u32 s42, s42, 20480
    s_mov_b32 m0, s42
    s_mov_b32 s43, 2130688
    buffer_load_dwordx4 v6, s[12:15], s43 offen lds
    s_lshl_b32 s42, s40, 10
    s_add_u32 s42, s42, 24576
    s_mov_b32 m0, s42
    s_mov_b32 s43, 2163456
    buffer_load_dwordx4 v6, s[12:15], s43 offen lds
    s_lshl_b32 s42, s40, 10
    s_add_u32 s42, s42, 28672
    s_mov_b32 m0, s42
    s_mov_b32 s43, 2196224
    buffer_load_dwordx4 v6, s[12:15], s43 offen lds
    v_add_u32 v24, 32768, v16
    v_add_u32 v25, 32768, v17
    v_add_u32 v26, 32768, v18
    v_add_u32 v27, 32768, v19
    v_add_u32 v28, 32768, v20
    v_add_u32 v29, 32768, v21
    v_add_u32 v30, 32768, v22
    v_add_u32 v31, 32768, v23
    ds_read_b128 v[32:35], v24 offset:0
    ds_read_b128 v[36:39], v24 offset:4096
    ds_read_b128 v[48:51], v28 offset:0
    ds_read_b128 v[52:55], v28 offset:4096
    ds_read_b128 v[40:43], v25 offset:0
    ds_read_b128 v[44:47], v25 offset:4096
    ds_read_b128 v[56:59], v29 offset:0
    ds_read_b128 v[60:63], v29 offset:4096
    s_waitcnt lgkmcnt(4)
    v_mfma_f32_32x32x16_bf16 v[64:79], v[32:35], v[48:51], v[64:79]
    v_mfma_f32_32x32x16_bf16 v[80:95], v[32:35], v[52:55], v[80:95]
    v_mfma_f32_32x32x16_bf16 v[96:111], v[36:39], v[48:51], v[96:111]
    v_mfma_f32_32x32x16_bf16 v[112:127], v[36:39], v[52:55], v[112:127]
    ds_read_b128 v[32:35], v26 offset:0
    ds_read_b128 v[36:39], v26 offset:4096
    ds_read_b128 v[48:51], v30 offset:0
    ds_read_b128 v[52:55], v30 offset:4096
    s_waitcnt lgkmcnt(4)
    v_mfma_f32_32x32x16_bf16 v[64:79], v[40:43], v[56:59], v[64:79]
    v_mfma_f32_32x32x16_bf16 v[80:95], v[40:43], v[60:63], v[80:95]
    v_mfma_f32_32x32x16_bf16 v[96:111], v[44:47], v[56:59], v[96:111]
    v_mfma_f32_32x32x16_bf16 v[112:127], v[44:47], v[60:63], v[112:127]
    ds_read_b128 v[40:43], v27 offset:0
    ds_read_b128 v[44:47], v27 offset:4096
    ds_read_b128 v[56:59], v31 offset:0
    ds_read_b128 v[60:63], v31 offset:4096
    s_waitcnt lgkmcnt(4)
    v_mfma_f32_32x32x16_bf16 v[64:79], v[32:35], v[48:51], v[64:79]
    v_mfma_f32_32x32x16_bf16 v[80:95], v[32:35], v[52:55], v[80:95]
    v_mfma_f32_32x32x16_bf16 v[96:111], v[36:39], v[48:51], v[96:111]
    v_mfma_f32_32x32x16_bf16 v[112:127], v[36:39], v[52:55], v[112:127]
    s_waitcnt lgkmcnt(0)
    v_mfma_f32_32x32x16_bf16 v[64:79], v[40:43], v[56:59], v[64:79]
    v_mfma_f32_32x32x16_bf16 v[80:95], v[40:43], v[60:63], v[80:95]
    v_mfma_f32_32x32x16_bf16 v[96:111], v[44:47], v[56:59], v[96:111]
    v_mfma_f32_32x32x16_bf16 v[112:127], v[44:47], v[60:63], v[112:127]
    s_waitcnt vmcnt(0)
    s_barrier
    s_lshl_b32 s42, s40, 10
    s_add_u32 s42, s42, 32768
    s_mov_b32 m0, s42
    s_mov_b32 s43, 6423424
    buffer_load_dwordx4 v5, s[12:15], s43 offen lds
    s_lshl_b32 s42, s40, 10
    s_add_u32 s42, s42, 36864
    s_mov_b32 m0, s42
    s_mov_b32 s43, 6456192
    buffer_load_dwordx4 v5, s[12:15], s43 offen lds
    s_lshl_b32 s42, s40, 10
    s_add_u32 s42, s42, 40960
    s_mov_b32 m0, s42
    s_mov_b32 s43, 6488960
    buffer_load_dwordx4 v5, s[12:15], s43 offen lds
    s_lshl_b32 s42, s40, 10
    s_add_u32 s42, s42, 45056
    s_mov_b32 m0, s42
    s_mov_b32 s43, 6521728
    buffer_load_dwordx4 v5, s[12:15], s43 offen lds
    s_lshl_b32 s42, s40, 10
    s_add_u32 s42, s42, 49152
    s_mov_b32 m0, s42
    s_mov_b32 s43, 2098048
    buffer_load_dwordx4 v6, s[12:15], s43 offen lds
    s_lshl_b32 s42, s40, 10
    s_add_u32 s42, s42, 53248
    s_mov_b32 m0, s42
    s_mov_b32 s43, 2130816
    buffer_load_dwordx4 v6, s[12:15], s43 offen lds
    s_lshl_b32 s42, s40, 10
    s_add_u32 s42, s42, 57344
    s_mov_b32 m0, s42
    s_mov_b32 s43, 2163584
    buffer_load_dwordx4 v6, s[12:15], s43 offen lds
    s_lshl_b32 s42, s40, 10
    s_add_u32 s42, s42, 61440
    s_mov_b32 m0, s42
    s_mov_b32 s43, 2196352
    buffer_load_dwordx4 v6, s[12:15], s43 offen lds
    v_add_u32 v24, 0, v16
    v_add_u32 v25, 0, v17
    v_add_u32 v26, 0, v18
    v_add_u32 v27, 0, v19
    v_add_u32 v28, 0, v20
    v_add_u32 v29, 0, v21
    v_add_u32 v30, 0, v22
    v_add_u32 v31, 0, v23
    ds_read_b128 v[32:35], v24 offset:0
    ds_read_b128 v[36:39], v24 offset:4096
    ds_read_b128 v[48:51], v28 offset:0
    ds_read_b128 v[52:55], v28 offset:4096
    ds_read_b128 v[40:43], v25 offset:0
    ds_read_b128 v[44:47], v25 offset:4096
    ds_read_b128 v[56:59], v29 offset:0
    ds_read_b128 v[60:63], v29 offset:4096
    s_waitcnt lgkmcnt(4)
    v_mfma_f32_32x32x16_bf16 v[64:79], v[32:35], v[48:51], v[64:79]
    v_mfma_f32_32x32x16_bf16 v[80:95], v[32:35], v[52:55], v[80:95]
    v_mfma_f32_32x32x16_bf16 v[96:111], v[36:39], v[48:51], v[96:111]
    v_mfma_f32_32x32x16_bf16 v[112:127], v[36:39], v[52:55], v[112:127]
    ds_read_b128 v[32:35], v26 offset:0
    ds_read_b128 v[36:39], v26 offset:4096
    ds_read_b128 v[48:51], v30 offset:0
    ds_read_b128 v[52:55], v30 offset:4096
    s_waitcnt lgkmcnt(4)
    v_mfma_f32_32x32x16_bf16 v[64:79], v[40:43], v[56:59], v[64:79]
    v_mfma_f32_32x32x16_bf16 v[80:95], v[40:43], v[60:63], v[80:95]
    v_mfma_f32_32x32x16_bf16 v[96:111], v[44:47], v[56:59], v[96:111]
    v_mfma_f32_32x32x16_bf16 v[112:127], v[44:47], v[60:63], v[112:127]
    ds_read_b128 v[40:43], v27 offset:0
    ds_read_b128 v[44:47], v27 offset:4096
    ds_read_b128 v[56:59], v31 offset:0
    ds_read_b128 v[60:63], v31 offset:4096
    s_waitcnt lgkmcnt(4)
    v_mfma_f32_32x32x16_bf16 v[64:79], v[32:35], v[48:51], v[64:79]
    v_mfma_f32_32x32x16_bf16 v[80:95], v[32:35], v[52:55], v[80:95]
    v_mfma_f32_32x32x16_bf16 v[96:111], v[36:39], v[48:51], v[96:111]
    v_mfma_f32_32x32x16_bf16 v[112:127], v[36:39], v[52:55], v[112:127]
    s_waitcnt lgkmcnt(0)
    v_mfma_f32_32x32x16_bf16 v[64:79], v[40:43], v[56:59], v[64:79]
    v_mfma_f32_32x32x16_bf16 v[80:95], v[40:43], v[60:63], v[80:95]
    v_mfma_f32_32x32x16_bf16 v[96:111], v[44:47], v[56:59], v[96:111]
    v_mfma_f32_32x32x16_bf16 v[112:127], v[44:47], v[60:63], v[112:127]
    s_waitcnt vmcnt(0)
    s_barrier
    v_add_u32 v24, 32768, v16
    v_add_u32 v25, 32768, v17
    v_add_u32 v26, 32768, v18
    v_add_u32 v27, 32768, v19
    v_add_u32 v28, 32768, v20
    v_add_u32 v29, 32768, v21
    v_add_u32 v30, 32768, v22
    v_add_u32 v31, 32768, v23
    ds_read_b128 v[32:35], v24 offset:0
    ds_read_b128 v[36:39], v24 offset:4096
    ds_read_b128 v[48:51], v28 offset:0
    ds_read_b128 v[52:55], v28 offset:4096
    ds_read_b128 v[40:43], v25 offset:0
    ds_read_b128 v[44:47], v25 offset:4096
    ds_read_b128 v[56:59], v29 offset:0
    ds_read_b128 v[60:63], v29 offset:4096
    s_waitcnt lgkmcnt(4)
    v_mfma_f32_32x32x16_bf16 v[64:79], v[32:35], v[48:51], v[64:79]
    v_mfma_f32_32x32x16_bf16 v[80:95], v[32:35], v[52:55], v[80:95]
    v_mfma_f32_32x32x16_bf16 v[96:111], v[36:39], v[48:51], v[96:111]
    v_mfma_f32_32x32x16_bf16 v[112:127], v[36:39], v[52:55], v[112:127]
    ds_read_b128 v[32:35], v26 offset:0
    ds_read_b128 v[36:39], v26 offset:4096
    ds_read_b128 v[48:51], v30 offset:0
    ds_read_b128 v[52:55], v30 offset:4096
    s_waitcnt lgkmcnt(4)
    v_mfma_f32_32x32x16_bf16 v[64:79], v[40:43], v[56:59], v[64:79]
    v_mfma_f32_32x32x16_bf16 v[80:95], v[40:43], v[60:63], v[80:95]
    v_mfma_f32_32x32x16_bf16 v[96:111], v[44:47], v[56:59], v[96:111]
    v_mfma_f32_32x32x16_bf16 v[112:127], v[44:47], v[60:63], v[112:127]
    ds_read_b128 v[40:43], v27 offset:0
    ds_read_b128 v[44:47], v27 offset:4096
    ds_read_b128 v[56:59], v31 offset:0
    ds_read_b128 v[60:63], v31 offset:4096
    s_waitcnt lgkmcnt(4)
    v_mfma_f32_32x32x16_bf16 v[64:79], v[32:35], v[48:51], v[64:79]
    v_mfma_f32_32x32x16_bf16 v[80:95], v[32:35], v[52:55], v[80:95]
    v_mfma_f32_32x32x16_bf16 v[96:111], v[36:39], v[48:51], v[96:111]
    v_mfma_f32_32x32x16_bf16 v[112:127], v[36:39], v[52:55], v[112:127]
    s_waitcnt lgkmcnt(0)
    v_mfma_f32_32x32x16_bf16 v[64:79], v[40:43], v[56:59], v[64:79]
    v_mfma_f32_32x32x16_bf16 v[80:95], v[40:43], v[60:63], v[80:95]
    v_mfma_f32_32x32x16_bf16 v[96:111], v[44:47], v[56:59], v[96:111]
    v_mfma_f32_32x32x16_bf16 v[112:127], v[44:47], v[60:63], v[112:127]
    s_nop 7
    s_nop 7
    v_lshlrev_b32 v12, 6, v10
    v_lshl_add_u32 v12, v8, 2, v12
    v_add_u32 v12, s44, v12
    v_lshlrev_b32 v13, 1, v12
    v_lshlrev_b32 v30, 6, v11
    v_add_u32 v30, v30, v7
    v_add_u32 v30, s45, v30
    s_movk_i32 s41, 3584
    v_mul_lo_u32 v30, v30, s41
    v_add_u32 v30, v30, v13
    v_add_u32 v30, 0x9a0000, v30
    v_cvt_pk_bf16_f32 v64, v64, v64
    v_lshlrev_b32 v64, 16, v64
    v_lshlrev_b32 v31, 16, v128
    v_add_f32 v64, v64, v31
    v_cvt_pk_bf16_f32 v64, v64, v64
    v_lshlrev_b32 v64, 16, v64
    v_mul_f32 v31, v64, v64
    v_mul_f32 v31, v31, v64
    v_mul_f32 v31, 0x3d372713, v31
    v_add_f32 v31, v31, v64
    v_mul_f32 v31, 0xc0135761, v31
    v_exp_f32 v31, v31
    s_nop 0
    v_add_f32 v31, 1.0, v31
    v_rcp_f32 v31, v31
    s_nop 0
    v_mul_f32 v64, v64, v31
    v_cvt_pk_bf16_f32 v64, v64, v64
    v_lshlrev_b32 v64, 16, v64
    v_cvt_pk_bf16_f32 v65, v65, v65
    v_lshlrev_b32 v65, 16, v65
    v_and_b32 v31, 0xffff0000, v128
    v_add_f32 v65, v65, v31
    v_cvt_pk_bf16_f32 v65, v65, v65
    v_lshlrev_b32 v65, 16, v65
    v_mul_f32 v31, v65, v65
    v_mul_f32 v31, v31, v65
    v_mul_f32 v31, 0x3d372713, v31
    v_add_f32 v31, v31, v65
    v_mul_f32 v31, 0xc0135761, v31
    v_exp_f32 v31, v31
    s_nop 0
    v_add_f32 v31, 1.0, v31
    v_rcp_f32 v31, v31
    s_nop 0
    v_mul_f32 v65, v65, v31
    v_cvt_pk_bf16_f32 v65, v65, v65
    v_lshlrev_b32 v65, 16, v65
    v_cvt_pk_bf16_f32 v66, v66, v66
    v_lshlrev_b32 v66, 16, v66
    v_lshlrev_b32 v31, 16, v129
    v_add_f32 v66, v66, v31
    v_cvt_pk_bf16_f32 v66, v66, v66
    v_lshlrev_b32 v66, 16, v66
    v_mul_f32 v31, v66, v66
    v_mul_f32 v31, v31, v66
    v_mul_f32 v31, 0x3d372713, v31
    v_add_f32 v31, v31, v66
    v_mul_f32 v31, 0xc0135761, v31
    v_exp_f32 v31, v31
    s_nop 0
    v_add_f32 v31, 1.0, v31
    v_rcp_f32 v31, v31
    s_nop 0
    v_mul_f32 v66, v66, v31
    v_cvt_pk_bf16_f32 v66, v66, v66
    v_lshlrev_b32 v66, 16, v66
    v_cvt_pk_bf16_f32 v67, v67, v67
    v_lshlrev_b32 v67, 16, v67
    v_and_b32 v31, 0xffff0000, v129
    v_add_f32 v67, v67, v31
    v_cvt_pk_bf16_f32 v67, v67, v67
    v_lshlrev_b32 v67, 16, v67
    v_mul_f32 v31, v67, v67
    v_mul_f32 v31, v31, v67
    v_mul_f32 v31, 0x3d372713, v31
    v_add_f32 v31, v31, v67
    v_mul_f32 v31, 0xc0135761, v31
    v_exp_f32 v31, v31
    s_nop 0
    v_add_f32 v31, 1.0, v31
    v_rcp_f32 v31, v31
    s_nop 0
    v_mul_f32 v67, v67, v31
    v_cvt_pk_bf16_f32 v67, v67, v67
    v_lshlrev_b32 v67, 16, v67
    v_cvt_pk_bf16_f32 v32, v64, v65
    v_cvt_pk_bf16_f32 v33, v66, v67
    buffer_store_dwordx2 v[32:33], v30, s[12:15], 0 offen offset:0
    v_cvt_pk_bf16_f32 v68, v68, v68
    v_lshlrev_b32 v68, 16, v68
    v_lshlrev_b32 v31, 16, v130
    v_add_f32 v68, v68, v31
    v_cvt_pk_bf16_f32 v68, v68, v68
    v_lshlrev_b32 v68, 16, v68
    v_mul_f32 v31, v68, v68
    v_mul_f32 v31, v31, v68
    v_mul_f32 v31, 0x3d372713, v31
    v_add_f32 v31, v31, v68
    v_mul_f32 v31, 0xc0135761, v31
    v_exp_f32 v31, v31
    s_nop 0
    v_add_f32 v31, 1.0, v31
    v_rcp_f32 v31, v31
    s_nop 0
    v_mul_f32 v68, v68, v31
    v_cvt_pk_bf16_f32 v68, v68, v68
    v_lshlrev_b32 v68, 16, v68
    v_cvt_pk_bf16_f32 v69, v69, v69
    v_lshlrev_b32 v69, 16, v69
    v_and_b32 v31, 0xffff0000, v130
    v_add_f32 v69, v69, v31
    v_cvt_pk_bf16_f32 v69, v69, v69
    v_lshlrev_b32 v69, 16, v69
    v_mul_f32 v31, v69, v69
    v_mul_f32 v31, v31, v69
    v_mul_f32 v31, 0x3d372713, v31
    v_add_f32 v31, v31, v69
    v_mul_f32 v31, 0xc0135761, v31
    v_exp_f32 v31, v31
    s_nop 0
    v_add_f32 v31, 1.0, v31
    v_rcp_f32 v31, v31
    s_nop 0
    v_mul_f32 v69, v69, v31
    v_cvt_pk_bf16_f32 v69, v69, v69
    v_lshlrev_b32 v69, 16, v69
    v_cvt_pk_bf16_f32 v70, v70, v70
    v_lshlrev_b32 v70, 16, v70
    v_lshlrev_b32 v31, 16, v131
    v_add_f32 v70, v70, v31
    v_cvt_pk_bf16_f32 v70, v70, v70
    v_lshlrev_b32 v70, 16, v70
    v_mul_f32 v31, v70, v70
    v_mul_f32 v31, v31, v70
    v_mul_f32 v31, 0x3d372713, v31
    v_add_f32 v31, v31, v70
    v_mul_f32 v31, 0xc0135761, v31
    v_exp_f32 v31, v31
    s_nop 0
    v_add_f32 v31, 1.0, v31
    v_rcp_f32 v31, v31
    s_nop 0
    v_mul_f32 v70, v70, v31
    v_cvt_pk_bf16_f32 v70, v70, v70
    v_lshlrev_b32 v70, 16, v70
    v_cvt_pk_bf16_f32 v71, v71, v71
    v_lshlrev_b32 v71, 16, v71
    v_and_b32 v31, 0xffff0000, v131
    v_add_f32 v71, v71, v31
    v_cvt_pk_bf16_f32 v71, v71, v71
    v_lshlrev_b32 v71, 16, v71
    v_mul_f32 v31, v71, v71
    v_mul_f32 v31, v31, v71
    v_mul_f32 v31, 0x3d372713, v31
    v_add_f32 v31, v31, v71
    v_mul_f32 v31, 0xc0135761, v31
    v_exp_f32 v31, v31
    s_nop 0
    v_add_f32 v31, 1.0, v31
    v_rcp_f32 v31, v31
    s_nop 0
    v_mul_f32 v71, v71, v31
    v_cvt_pk_bf16_f32 v71, v71, v71
    v_lshlrev_b32 v71, 16, v71
    v_cvt_pk_bf16_f32 v34, v68, v69
    v_cvt_pk_bf16_f32 v35, v70, v71
    buffer_store_dwordx2 v[34:35], v30, s[12:15], 0 offen offset:16
    v_cvt_pk_bf16_f32 v72, v72, v72
    v_lshlrev_b32 v72, 16, v72
    v_lshlrev_b32 v31, 16, v132
    v_add_f32 v72, v72, v31
    v_cvt_pk_bf16_f32 v72, v72, v72
    v_lshlrev_b32 v72, 16, v72
    v_mul_f32 v31, v72, v72
    v_mul_f32 v31, v31, v72
    v_mul_f32 v31, 0x3d372713, v31
    v_add_f32 v31, v31, v72
    v_mul_f32 v31, 0xc0135761, v31
    v_exp_f32 v31, v31
    s_nop 0
    v_add_f32 v31, 1.0, v31
    v_rcp_f32 v31, v31
    s_nop 0
    v_mul_f32 v72, v72, v31
    v_cvt_pk_bf16_f32 v72, v72, v72
    v_lshlrev_b32 v72, 16, v72
    v_cvt_pk_bf16_f32 v73, v73, v73
    v_lshlrev_b32 v73, 16, v73
    v_and_b32 v31, 0xffff0000, v132
    v_add_f32 v73, v73, v31
    v_cvt_pk_bf16_f32 v73, v73, v73
    v_lshlrev_b32 v73, 16, v73
    v_mul_f32 v31, v73, v73
    v_mul_f32 v31, v31, v73
    v_mul_f32 v31, 0x3d372713, v31
    v_add_f32 v31, v31, v73
    v_mul_f32 v31, 0xc0135761, v31
    v_exp_f32 v31, v31
    s_nop 0
    v_add_f32 v31, 1.0, v31
    v_rcp_f32 v31, v31
    s_nop 0
    v_mul_f32 v73, v73, v31
    v_cvt_pk_bf16_f32 v73, v73, v73
    v_lshlrev_b32 v73, 16, v73
    v_cvt_pk_bf16_f32 v74, v74, v74
    v_lshlrev_b32 v74, 16, v74
    v_lshlrev_b32 v31, 16, v133
    v_add_f32 v74, v74, v31
    v_cvt_pk_bf16_f32 v74, v74, v74
    v_lshlrev_b32 v74, 16, v74
    v_mul_f32 v31, v74, v74
    v_mul_f32 v31, v31, v74
    v_mul_f32 v31, 0x3d372713, v31
    v_add_f32 v31, v31, v74
    v_mul_f32 v31, 0xc0135761, v31
    v_exp_f32 v31, v31
    s_nop 0
    v_add_f32 v31, 1.0, v31
    v_rcp_f32 v31, v31
    s_nop 0
    v_mul_f32 v74, v74, v31
    v_cvt_pk_bf16_f32 v74, v74, v74
    v_lshlrev_b32 v74, 16, v74
    v_cvt_pk_bf16_f32 v75, v75, v75
    v_lshlrev_b32 v75, 16, v75
    v_and_b32 v31, 0xffff0000, v133
    v_add_f32 v75, v75, v31
    v_cvt_pk_bf16_f32 v75, v75, v75
    v_lshlrev_b32 v75, 16, v75
    v_mul_f32 v31, v75, v75
    v_mul_f32 v31, v31, v75
    v_mul_f32 v31, 0x3d372713, v31
    v_add_f32 v31, v31, v75
    v_mul_f32 v31, 0xc0135761, v31
    v_exp_f32 v31, v31
    s_nop 0
    v_add_f32 v31, 1.0, v31
    v_rcp_f32 v31, v31
    s_nop 0
    v_mul_f32 v75, v75, v31
    v_cvt_pk_bf16_f32 v75, v75, v75
    v_lshlrev_b32 v75, 16, v75
    v_cvt_pk_bf16_f32 v36, v72, v73
    v_cvt_pk_bf16_f32 v37, v74, v75
    buffer_store_dwordx2 v[36:37], v30, s[12:15], 0 offen offset:32
    v_cvt_pk_bf16_f32 v76, v76, v76
    v_lshlrev_b32 v76, 16, v76
    v_lshlrev_b32 v31, 16, v134
    v_add_f32 v76, v76, v31
    v_cvt_pk_bf16_f32 v76, v76, v76
    v_lshlrev_b32 v76, 16, v76
    v_mul_f32 v31, v76, v76
    v_mul_f32 v31, v31, v76
    v_mul_f32 v31, 0x3d372713, v31
    v_add_f32 v31, v31, v76
    v_mul_f32 v31, 0xc0135761, v31
    v_exp_f32 v31, v31
    s_nop 0
    v_add_f32 v31, 1.0, v31
    v_rcp_f32 v31, v31
    s_nop 0
    v_mul_f32 v76, v76, v31
    v_cvt_pk_bf16_f32 v76, v76, v76
    v_lshlrev_b32 v76, 16, v76
    v_cvt_pk_bf16_f32 v77, v77, v77
    v_lshlrev_b32 v77, 16, v77
    v_and_b32 v31, 0xffff0000, v134
    v_add_f32 v77, v77, v31
    v_cvt_pk_bf16_f32 v77, v77, v77
    v_lshlrev_b32 v77, 16, v77
    v_mul_f32 v31, v77, v77
    v_mul_f32 v31, v31, v77
    v_mul_f32 v31, 0x3d372713, v31
    v_add_f32 v31, v31, v77
    v_mul_f32 v31, 0xc0135761, v31
    v_exp_f32 v31, v31
    s_nop 0
    v_add_f32 v31, 1.0, v31
    v_rcp_f32 v31, v31
    s_nop 0
    v_mul_f32 v77, v77, v31
    v_cvt_pk_bf16_f32 v77, v77, v77
    v_lshlrev_b32 v77, 16, v77
    v_cvt_pk_bf16_f32 v78, v78, v78
    v_lshlrev_b32 v78, 16, v78
    v_lshlrev_b32 v31, 16, v135
    v_add_f32 v78, v78, v31
    v_cvt_pk_bf16_f32 v78, v78, v78
    v_lshlrev_b32 v78, 16, v78
    v_mul_f32 v31, v78, v78
    v_mul_f32 v31, v31, v78
    v_mul_f32 v31, 0x3d372713, v31
    v_add_f32 v31, v31, v78
    v_mul_f32 v31, 0xc0135761, v31
    v_exp_f32 v31, v31
    s_nop 0
    v_add_f32 v31, 1.0, v31
    v_rcp_f32 v31, v31
    s_nop 0
    v_mul_f32 v78, v78, v31
    v_cvt_pk_bf16_f32 v78, v78, v78
    v_lshlrev_b32 v78, 16, v78
    v_cvt_pk_bf16_f32 v79, v79, v79
    v_lshlrev_b32 v79, 16, v79
    v_and_b32 v31, 0xffff0000, v135
    v_add_f32 v79, v79, v31
    v_cvt_pk_bf16_f32 v79, v79, v79
    v_lshlrev_b32 v79, 16, v79
    v_mul_f32 v31, v79, v79
    v_mul_f32 v31, v31, v79
    v_mul_f32 v31, 0x3d372713, v31
    v_add_f32 v31, v31, v79
    v_mul_f32 v31, 0xc0135761, v31
    v_exp_f32 v31, v31
    s_nop 0
    v_add_f32 v31, 1.0, v31
    v_rcp_f32 v31, v31
    s_nop 0
    v_mul_f32 v79, v79, v31
    v_cvt_pk_bf16_f32 v79, v79, v79
    v_lshlrev_b32 v79, 16, v79
    v_cvt_pk_bf16_f32 v38, v76, v77
    v_cvt_pk_bf16_f32 v39, v78, v79
    buffer_store_dwordx2 v[38:39], v30, s[12:15], 0 offen offset:48
    s_nop 1
    v_cvt_pk_bf16_f32 v96, v96, v96
    v_lshlrev_b32 v96, 16, v96
    v_lshlrev_b32 v31, 16, v136
    v_add_f32 v96, v96, v31
    v_cvt_pk_bf16_f32 v96, v96, v96
    v_lshlrev_b32 v96, 16, v96
    v_mul_f32 v31, v96, v96
    v_mul_f32 v31, v31, v96
    v_mul_f32 v31, 0x3d372713, v31
    v_add_f32 v31, v31, v96
    v_mul_f32 v31, 0xc0135761, v31
    v_exp_f32 v31, v31
    s_nop 0
    v_add_f32 v31, 1.0, v31
    v_rcp_f32 v31, v31
    s_nop 0
    v_mul_f32 v96, v96, v31
    v_cvt_pk_bf16_f32 v96, v96, v96
    v_lshlrev_b32 v96, 16, v96
    v_cvt_pk_bf16_f32 v97, v97, v97
    v_lshlrev_b32 v97, 16, v97
    v_and_b32 v31, 0xffff0000, v136
    v_add_f32 v97, v97, v31
    v_cvt_pk_bf16_f32 v97, v97, v97
    v_lshlrev_b32 v97, 16, v97
    v_mul_f32 v31, v97, v97
    v_mul_f32 v31, v31, v97
    v_mul_f32 v31, 0x3d372713, v31
    v_add_f32 v31, v31, v97
    v_mul_f32 v31, 0xc0135761, v31
    v_exp_f32 v31, v31
    s_nop 0
    v_add_f32 v31, 1.0, v31
    v_rcp_f32 v31, v31
    s_nop 0
    v_mul_f32 v97, v97, v31
    v_cvt_pk_bf16_f32 v97, v97, v97
    v_lshlrev_b32 v97, 16, v97
    v_cvt_pk_bf16_f32 v98, v98, v98
    v_lshlrev_b32 v98, 16, v98
    v_lshlrev_b32 v31, 16, v137
    v_add_f32 v98, v98, v31
    v_cvt_pk_bf16_f32 v98, v98, v98
    v_lshlrev_b32 v98, 16, v98
    v_mul_f32 v31, v98, v98
    v_mul_f32 v31, v31, v98
    v_mul_f32 v31, 0x3d372713, v31
    v_add_f32 v31, v31, v98
    v_mul_f32 v31, 0xc0135761, v31
    v_exp_f32 v31, v31
    s_nop 0
    v_add_f32 v31, 1.0, v31
    v_rcp_f32 v31, v31
    s_nop 0
    v_mul_f32 v98, v98, v31
    v_cvt_pk_bf16_f32 v98, v98, v98
    v_lshlrev_b32 v98, 16, v98
    v_cvt_pk_bf16_f32 v99, v99, v99
    v_lshlrev_b32 v99, 16, v99
    v_and_b32 v31, 0xffff0000, v137
    v_add_f32 v99, v99, v31
    v_cvt_pk_bf16_f32 v99, v99, v99
    v_lshlrev_b32 v99, 16, v99
    v_mul_f32 v31, v99, v99
    v_mul_f32 v31, v31, v99
    v_mul_f32 v31, 0x3d372713, v31
    v_add_f32 v31, v31, v99
    v_mul_f32 v31, 0xc0135761, v31
    v_exp_f32 v31, v31
    s_nop 0
    v_add_f32 v31, 1.0, v31
    v_rcp_f32 v31, v31
    s_nop 0
    v_mul_f32 v99, v99, v31
    v_cvt_pk_bf16_f32 v99, v99, v99
    v_lshlrev_b32 v99, 16, v99
    v_cvt_pk_bf16_f32 v32, v96, v97
    v_cvt_pk_bf16_f32 v33, v98, v99
    buffer_store_dwordx2 v[32:33], v30, s[12:15], 0 offen offset:64
    v_cvt_pk_bf16_f32 v100, v100, v100
    v_lshlrev_b32 v100, 16, v100
    v_lshlrev_b32 v31, 16, v138
    v_add_f32 v100, v100, v31
    v_cvt_pk_bf16_f32 v100, v100, v100
    v_lshlrev_b32 v100, 16, v100
    v_mul_f32 v31, v100, v100
    v_mul_f32 v31, v31, v100
    v_mul_f32 v31, 0x3d372713, v31
    v_add_f32 v31, v31, v100
    v_mul_f32 v31, 0xc0135761, v31
    v_exp_f32 v31, v31
    s_nop 0
    v_add_f32 v31, 1.0, v31
    v_rcp_f32 v31, v31
    s_nop 0
    v_mul_f32 v100, v100, v31
    v_cvt_pk_bf16_f32 v100, v100, v100
    v_lshlrev_b32 v100, 16, v100
    v_cvt_pk_bf16_f32 v101, v101, v101
    v_lshlrev_b32 v101, 16, v101
    v_and_b32 v31, 0xffff0000, v138
    v_add_f32 v101, v101, v31
    v_cvt_pk_bf16_f32 v101, v101, v101
    v_lshlrev_b32 v101, 16, v101
    v_mul_f32 v31, v101, v101
    v_mul_f32 v31, v31, v101
    v_mul_f32 v31, 0x3d372713, v31
    v_add_f32 v31, v31, v101
    v_mul_f32 v31, 0xc0135761, v31
    v_exp_f32 v31, v31
    s_nop 0
    v_add_f32 v31, 1.0, v31
    v_rcp_f32 v31, v31
    s_nop 0
    v_mul_f32 v101, v101, v31
    v_cvt_pk_bf16_f32 v101, v101, v101
    v_lshlrev_b32 v101, 16, v101
    v_cvt_pk_bf16_f32 v102, v102, v102
    v_lshlrev_b32 v102, 16, v102
    v_lshlrev_b32 v31, 16, v139
    v_add_f32 v102, v102, v31
    v_cvt_pk_bf16_f32 v102, v102, v102
    v_lshlrev_b32 v102, 16, v102
    v_mul_f32 v31, v102, v102
    v_mul_f32 v31, v31, v102
    v_mul_f32 v31, 0x3d372713, v31
    v_add_f32 v31, v31, v102
    v_mul_f32 v31, 0xc0135761, v31
    v_exp_f32 v31, v31
    s_nop 0
    v_add_f32 v31, 1.0, v31
    v_rcp_f32 v31, v31
    s_nop 0
    v_mul_f32 v102, v102, v31
    v_cvt_pk_bf16_f32 v102, v102, v102
    v_lshlrev_b32 v102, 16, v102
    v_cvt_pk_bf16_f32 v103, v103, v103
    v_lshlrev_b32 v103, 16, v103
    v_and_b32 v31, 0xffff0000, v139
    v_add_f32 v103, v103, v31
    v_cvt_pk_bf16_f32 v103, v103, v103
    v_lshlrev_b32 v103, 16, v103
    v_mul_f32 v31, v103, v103
    v_mul_f32 v31, v31, v103
    v_mul_f32 v31, 0x3d372713, v31
    v_add_f32 v31, v31, v103
    v_mul_f32 v31, 0xc0135761, v31
    v_exp_f32 v31, v31
    s_nop 0
    v_add_f32 v31, 1.0, v31
    v_rcp_f32 v31, v31
    s_nop 0
    v_mul_f32 v103, v103, v31
    v_cvt_pk_bf16_f32 v103, v103, v103
    v_lshlrev_b32 v103, 16, v103
    v_cvt_pk_bf16_f32 v34, v100, v101
    v_cvt_pk_bf16_f32 v35, v102, v103
    buffer_store_dwordx2 v[34:35], v30, s[12:15], 0 offen offset:80
    v_cvt_pk_bf16_f32 v104, v104, v104
    v_lshlrev_b32 v104, 16, v104
    v_lshlrev_b32 v31, 16, v140
    v_add_f32 v104, v104, v31
    v_cvt_pk_bf16_f32 v104, v104, v104
    v_lshlrev_b32 v104, 16, v104
    v_mul_f32 v31, v104, v104
    v_mul_f32 v31, v31, v104
    v_mul_f32 v31, 0x3d372713, v31
    v_add_f32 v31, v31, v104
    v_mul_f32 v31, 0xc0135761, v31
    v_exp_f32 v31, v31
    s_nop 0
    v_add_f32 v31, 1.0, v31
    v_rcp_f32 v31, v31
    s_nop 0
    v_mul_f32 v104, v104, v31
    v_cvt_pk_bf16_f32 v104, v104, v104
    v_lshlrev_b32 v104, 16, v104
    v_cvt_pk_bf16_f32 v105, v105, v105
    v_lshlrev_b32 v105, 16, v105
    v_and_b32 v31, 0xffff0000, v140
    v_add_f32 v105, v105, v31
    v_cvt_pk_bf16_f32 v105, v105, v105
    v_lshlrev_b32 v105, 16, v105
    v_mul_f32 v31, v105, v105
    v_mul_f32 v31, v31, v105
    v_mul_f32 v31, 0x3d372713, v31
    v_add_f32 v31, v31, v105
    v_mul_f32 v31, 0xc0135761, v31
    v_exp_f32 v31, v31
    s_nop 0
    v_add_f32 v31, 1.0, v31
    v_rcp_f32 v31, v31
    s_nop 0
    v_mul_f32 v105, v105, v31
    v_cvt_pk_bf16_f32 v105, v105, v105
    v_lshlrev_b32 v105, 16, v105
    v_cvt_pk_bf16_f32 v106, v106, v106
    v_lshlrev_b32 v106, 16, v106
    v_lshlrev_b32 v31, 16, v141
    v_add_f32 v106, v106, v31
    v_cvt_pk_bf16_f32 v106, v106, v106
    v_lshlrev_b32 v106, 16, v106
    v_mul_f32 v31, v106, v106
    v_mul_f32 v31, v31, v106
    v_mul_f32 v31, 0x3d372713, v31
    v_add_f32 v31, v31, v106
    v_mul_f32 v31, 0xc0135761, v31
    v_exp_f32 v31, v31
    s_nop 0
    v_add_f32 v31, 1.0, v31
    v_rcp_f32 v31, v31
    s_nop 0
    v_mul_f32 v106, v106, v31
    v_cvt_pk_bf16_f32 v106, v106, v106
    v_lshlrev_b32 v106, 16, v106
    v_cvt_pk_bf16_f32 v107, v107, v107
    v_lshlrev_b32 v107, 16, v107
    v_and_b32 v31, 0xffff0000, v141
    v_add_f32 v107, v107, v31
    v_cvt_pk_bf16_f32 v107, v107, v107
    v_lshlrev_b32 v107, 16, v107
    v_mul_f32 v31, v107, v107
    v_mul_f32 v31, v31, v107
    v_mul_f32 v31, 0x3d372713, v31
    v_add_f32 v31, v31, v107
    v_mul_f32 v31, 0xc0135761, v31
    v_exp_f32 v31, v31
    s_nop 0
    v_add_f32 v31, 1.0, v31
    v_rcp_f32 v31, v31
    s_nop 0
    v_mul_f32 v107, v107, v31
    v_cvt_pk_bf16_f32 v107, v107, v107
    v_lshlrev_b32 v107, 16, v107
    v_cvt_pk_bf16_f32 v36, v104, v105
    v_cvt_pk_bf16_f32 v37, v106, v107
    buffer_store_dwordx2 v[36:37], v30, s[12:15], 0 offen offset:96
    v_cvt_pk_bf16_f32 v108, v108, v108
    v_lshlrev_b32 v108, 16, v108
    v_lshlrev_b32 v31, 16, v142
    v_add_f32 v108, v108, v31
    v_cvt_pk_bf16_f32 v108, v108, v108
    v_lshlrev_b32 v108, 16, v108
    v_mul_f32 v31, v108, v108
    v_mul_f32 v31, v31, v108
    v_mul_f32 v31, 0x3d372713, v31
    v_add_f32 v31, v31, v108
    v_mul_f32 v31, 0xc0135761, v31
    v_exp_f32 v31, v31
    s_nop 0
    v_add_f32 v31, 1.0, v31
    v_rcp_f32 v31, v31
    s_nop 0
    v_mul_f32 v108, v108, v31
    v_cvt_pk_bf16_f32 v108, v108, v108
    v_lshlrev_b32 v108, 16, v108
    v_cvt_pk_bf16_f32 v109, v109, v109
    v_lshlrev_b32 v109, 16, v109
    v_and_b32 v31, 0xffff0000, v142
    v_add_f32 v109, v109, v31
    v_cvt_pk_bf16_f32 v109, v109, v109
    v_lshlrev_b32 v109, 16, v109
    v_mul_f32 v31, v109, v109
    v_mul_f32 v31, v31, v109
    v_mul_f32 v31, 0x3d372713, v31
    v_add_f32 v31, v31, v109
    v_mul_f32 v31, 0xc0135761, v31
    v_exp_f32 v31, v31
    s_nop 0
    v_add_f32 v31, 1.0, v31
    v_rcp_f32 v31, v31
    s_nop 0
    v_mul_f32 v109, v109, v31
    v_cvt_pk_bf16_f32 v109, v109, v109
    v_lshlrev_b32 v109, 16, v109
    v_cvt_pk_bf16_f32 v110, v110, v110
    v_lshlrev_b32 v110, 16, v110
    v_lshlrev_b32 v31, 16, v143
    v_add_f32 v110, v110, v31
    v_cvt_pk_bf16_f32 v110, v110, v110
    v_lshlrev_b32 v110, 16, v110
    v_mul_f32 v31, v110, v110
    v_mul_f32 v31, v31, v110
    v_mul_f32 v31, 0x3d372713, v31
    v_add_f32 v31, v31, v110
    v_mul_f32 v31, 0xc0135761, v31
    v_exp_f32 v31, v31
    s_nop 0
    v_add_f32 v31, 1.0, v31
    v_rcp_f32 v31, v31
    s_nop 0
    v_mul_f32 v110, v110, v31
    v_cvt_pk_bf16_f32 v110, v110, v110
    v_lshlrev_b32 v110, 16, v110
    v_cvt_pk_bf16_f32 v111, v111, v111
    v_lshlrev_b32 v111, 16, v111
    v_and_b32 v31, 0xffff0000, v143
    v_add_f32 v111, v111, v31
    v_cvt_pk_bf16_f32 v111, v111, v111
    v_lshlrev_b32 v111, 16, v111
    v_mul_f32 v31, v111, v111
    v_mul_f32 v31, v31, v111
    v_mul_f32 v31, 0x3d372713, v31
    v_add_f32 v31, v31, v111
    v_mul_f32 v31, 0xc0135761, v31
    v_exp_f32 v31, v31
    s_nop 0
    v_add_f32 v31, 1.0, v31
    v_rcp_f32 v31, v31
    s_nop 0
    v_mul_f32 v111, v111, v31
    v_cvt_pk_bf16_f32 v111, v111, v111
    v_lshlrev_b32 v111, 16, v111
    v_cvt_pk_bf16_f32 v38, v108, v109
    v_cvt_pk_bf16_f32 v39, v110, v111
    buffer_store_dwordx2 v[38:39], v30, s[12:15], 0 offen offset:112
    s_nop 1
    v_add_u32 v30, 114688, v30
    v_cvt_pk_bf16_f32 v80, v80, v80
    v_lshlrev_b32 v80, 16, v80
    v_lshlrev_b32 v31, 16, v128
    v_add_f32 v80, v80, v31
    v_cvt_pk_bf16_f32 v80, v80, v80
    v_lshlrev_b32 v80, 16, v80
    v_mul_f32 v31, v80, v80
    v_mul_f32 v31, v31, v80
    v_mul_f32 v31, 0x3d372713, v31
    v_add_f32 v31, v31, v80
    v_mul_f32 v31, 0xc0135761, v31
    v_exp_f32 v31, v31
    s_nop 0
    v_add_f32 v31, 1.0, v31
    v_rcp_f32 v31, v31
    s_nop 0
    v_mul_f32 v80, v80, v31
    v_cvt_pk_bf16_f32 v80, v80, v80
    v_lshlrev_b32 v80, 16, v80
    v_cvt_pk_bf16_f32 v81, v81, v81
    v_lshlrev_b32 v81, 16, v81
    v_and_b32 v31, 0xffff0000, v128
    v_add_f32 v81, v81, v31
    v_cvt_pk_bf16_f32 v81, v81, v81
    v_lshlrev_b32 v81, 16, v81
    v_mul_f32 v31, v81, v81
    v_mul_f32 v31, v31, v81
    v_mul_f32 v31, 0x3d372713, v31
    v_add_f32 v31, v31, v81
    v_mul_f32 v31, 0xc0135761, v31
    v_exp_f32 v31, v31
    s_nop 0
    v_add_f32 v31, 1.0, v31
    v_rcp_f32 v31, v31
    s_nop 0
    v_mul_f32 v81, v81, v31
    v_cvt_pk_bf16_f32 v81, v81, v81
    v_lshlrev_b32 v81, 16, v81
    v_cvt_pk_bf16_f32 v82, v82, v82
    v_lshlrev_b32 v82, 16, v82
    v_lshlrev_b32 v31, 16, v129
    v_add_f32 v82, v82, v31
    v_cvt_pk_bf16_f32 v82, v82, v82
    v_lshlrev_b32 v82, 16, v82
    v_mul_f32 v31, v82, v82
    v_mul_f32 v31, v31, v82
    v_mul_f32 v31, 0x3d372713, v31
    v_add_f32 v31, v31, v82
    v_mul_f32 v31, 0xc0135761, v31
    v_exp_f32 v31, v31
    s_nop 0
    v_add_f32 v31, 1.0, v31
    v_rcp_f32 v31, v31
    s_nop 0
    v_mul_f32 v82, v82, v31
    v_cvt_pk_bf16_f32 v82, v82, v82
    v_lshlrev_b32 v82, 16, v82
    v_cvt_pk_bf16_f32 v83, v83, v83
    v_lshlrev_b32 v83, 16, v83
    v_and_b32 v31, 0xffff0000, v129
    v_add_f32 v83, v83, v31
    v_cvt_pk_bf16_f32 v83, v83, v83
    v_lshlrev_b32 v83, 16, v83
    v_mul_f32 v31, v83, v83
    v_mul_f32 v31, v31, v83
    v_mul_f32 v31, 0x3d372713, v31
    v_add_f32 v31, v31, v83
    v_mul_f32 v31, 0xc0135761, v31
    v_exp_f32 v31, v31
    s_nop 0
    v_add_f32 v31, 1.0, v31
    v_rcp_f32 v31, v31
    s_nop 0
    v_mul_f32 v83, v83, v31
    v_cvt_pk_bf16_f32 v83, v83, v83
    v_lshlrev_b32 v83, 16, v83
    v_cvt_pk_bf16_f32 v32, v80, v81
    v_cvt_pk_bf16_f32 v33, v82, v83
    buffer_store_dwordx2 v[32:33], v30, s[12:15], 0 offen offset:0
    v_cvt_pk_bf16_f32 v84, v84, v84
    v_lshlrev_b32 v84, 16, v84
    v_lshlrev_b32 v31, 16, v130
    v_add_f32 v84, v84, v31
    v_cvt_pk_bf16_f32 v84, v84, v84
    v_lshlrev_b32 v84, 16, v84
    v_mul_f32 v31, v84, v84
    v_mul_f32 v31, v31, v84
    v_mul_f32 v31, 0x3d372713, v31
    v_add_f32 v31, v31, v84
    v_mul_f32 v31, 0xc0135761, v31
    v_exp_f32 v31, v31
    s_nop 0
    v_add_f32 v31, 1.0, v31
    v_rcp_f32 v31, v31
    s_nop 0
    v_mul_f32 v84, v84, v31
    v_cvt_pk_bf16_f32 v84, v84, v84
    v_lshlrev_b32 v84, 16, v84
    v_cvt_pk_bf16_f32 v85, v85, v85
    v_lshlrev_b32 v85, 16, v85
    v_and_b32 v31, 0xffff0000, v130
    v_add_f32 v85, v85, v31
    v_cvt_pk_bf16_f32 v85, v85, v85
    v_lshlrev_b32 v85, 16, v85
    v_mul_f32 v31, v85, v85
    v_mul_f32 v31, v31, v85
    v_mul_f32 v31, 0x3d372713, v31
    v_add_f32 v31, v31, v85
    v_mul_f32 v31, 0xc0135761, v31
    v_exp_f32 v31, v31
    s_nop 0
    v_add_f32 v31, 1.0, v31
    v_rcp_f32 v31, v31
    s_nop 0
    v_mul_f32 v85, v85, v31
    v_cvt_pk_bf16_f32 v85, v85, v85
    v_lshlrev_b32 v85, 16, v85
    v_cvt_pk_bf16_f32 v86, v86, v86
    v_lshlrev_b32 v86, 16, v86
    v_lshlrev_b32 v31, 16, v131
    v_add_f32 v86, v86, v31
    v_cvt_pk_bf16_f32 v86, v86, v86
    v_lshlrev_b32 v86, 16, v86
    v_mul_f32 v31, v86, v86
    v_mul_f32 v31, v31, v86
    v_mul_f32 v31, 0x3d372713, v31
    v_add_f32 v31, v31, v86
    v_mul_f32 v31, 0xc0135761, v31
    v_exp_f32 v31, v31
    s_nop 0
    v_add_f32 v31, 1.0, v31
    v_rcp_f32 v31, v31
    s_nop 0
    v_mul_f32 v86, v86, v31
    v_cvt_pk_bf16_f32 v86, v86, v86
    v_lshlrev_b32 v86, 16, v86
    v_cvt_pk_bf16_f32 v87, v87, v87
    v_lshlrev_b32 v87, 16, v87
    v_and_b32 v31, 0xffff0000, v131
    v_add_f32 v87, v87, v31
    v_cvt_pk_bf16_f32 v87, v87, v87
    v_lshlrev_b32 v87, 16, v87
    v_mul_f32 v31, v87, v87
    v_mul_f32 v31, v31, v87
    v_mul_f32 v31, 0x3d372713, v31
    v_add_f32 v31, v31, v87
    v_mul_f32 v31, 0xc0135761, v31
    v_exp_f32 v31, v31
    s_nop 0
    v_add_f32 v31, 1.0, v31
    v_rcp_f32 v31, v31
    s_nop 0
    v_mul_f32 v87, v87, v31
    v_cvt_pk_bf16_f32 v87, v87, v87
    v_lshlrev_b32 v87, 16, v87
    v_cvt_pk_bf16_f32 v34, v84, v85
    v_cvt_pk_bf16_f32 v35, v86, v87
    buffer_store_dwordx2 v[34:35], v30, s[12:15], 0 offen offset:16
    v_cvt_pk_bf16_f32 v88, v88, v88
    v_lshlrev_b32 v88, 16, v88
    v_lshlrev_b32 v31, 16, v132
    v_add_f32 v88, v88, v31
    v_cvt_pk_bf16_f32 v88, v88, v88
    v_lshlrev_b32 v88, 16, v88
    v_mul_f32 v31, v88, v88
    v_mul_f32 v31, v31, v88
    v_mul_f32 v31, 0x3d372713, v31
    v_add_f32 v31, v31, v88
    v_mul_f32 v31, 0xc0135761, v31
    v_exp_f32 v31, v31
    s_nop 0
    v_add_f32 v31, 1.0, v31
    v_rcp_f32 v31, v31
    s_nop 0
    v_mul_f32 v88, v88, v31
    v_cvt_pk_bf16_f32 v88, v88, v88
    v_lshlrev_b32 v88, 16, v88
    v_cvt_pk_bf16_f32 v89, v89, v89
    v_lshlrev_b32 v89, 16, v89
    v_and_b32 v31, 0xffff0000, v132
    v_add_f32 v89, v89, v31
    v_cvt_pk_bf16_f32 v89, v89, v89
    v_lshlrev_b32 v89, 16, v89
    v_mul_f32 v31, v89, v89
    v_mul_f32 v31, v31, v89
    v_mul_f32 v31, 0x3d372713, v31
    v_add_f32 v31, v31, v89
    v_mul_f32 v31, 0xc0135761, v31
    v_exp_f32 v31, v31
    s_nop 0
    v_add_f32 v31, 1.0, v31
    v_rcp_f32 v31, v31
    s_nop 0
    v_mul_f32 v89, v89, v31
    v_cvt_pk_bf16_f32 v89, v89, v89
    v_lshlrev_b32 v89, 16, v89
    v_cvt_pk_bf16_f32 v90, v90, v90
    v_lshlrev_b32 v90, 16, v90
    v_lshlrev_b32 v31, 16, v133
    v_add_f32 v90, v90, v31
    v_cvt_pk_bf16_f32 v90, v90, v90
    v_lshlrev_b32 v90, 16, v90
    v_mul_f32 v31, v90, v90
    v_mul_f32 v31, v31, v90
    v_mul_f32 v31, 0x3d372713, v31
    v_add_f32 v31, v31, v90
    v_mul_f32 v31, 0xc0135761, v31
    v_exp_f32 v31, v31
    s_nop 0
    v_add_f32 v31, 1.0, v31
    v_rcp_f32 v31, v31
    s_nop 0
    v_mul_f32 v90, v90, v31
    v_cvt_pk_bf16_f32 v90, v90, v90
    v_lshlrev_b32 v90, 16, v90
    v_cvt_pk_bf16_f32 v91, v91, v91
    v_lshlrev_b32 v91, 16, v91
    v_and_b32 v31, 0xffff0000, v133
    v_add_f32 v91, v91, v31
    v_cvt_pk_bf16_f32 v91, v91, v91
    v_lshlrev_b32 v91, 16, v91
    v_mul_f32 v31, v91, v91
    v_mul_f32 v31, v31, v91
    v_mul_f32 v31, 0x3d372713, v31
    v_add_f32 v31, v31, v91
    v_mul_f32 v31, 0xc0135761, v31
    v_exp_f32 v31, v31
    s_nop 0
    v_add_f32 v31, 1.0, v31
    v_rcp_f32 v31, v31
    s_nop 0
    v_mul_f32 v91, v91, v31
    v_cvt_pk_bf16_f32 v91, v91, v91
    v_lshlrev_b32 v91, 16, v91
    v_cvt_pk_bf16_f32 v36, v88, v89
    v_cvt_pk_bf16_f32 v37, v90, v91
    buffer_store_dwordx2 v[36:37], v30, s[12:15], 0 offen offset:32
    v_cvt_pk_bf16_f32 v92, v92, v92
    v_lshlrev_b32 v92, 16, v92
    v_lshlrev_b32 v31, 16, v134
    v_add_f32 v92, v92, v31
    v_cvt_pk_bf16_f32 v92, v92, v92
    v_lshlrev_b32 v92, 16, v92
    v_mul_f32 v31, v92, v92
    v_mul_f32 v31, v31, v92
    v_mul_f32 v31, 0x3d372713, v31
    v_add_f32 v31, v31, v92
    v_mul_f32 v31, 0xc0135761, v31
    v_exp_f32 v31, v31
    s_nop 0
    v_add_f32 v31, 1.0, v31
    v_rcp_f32 v31, v31
    s_nop 0
    v_mul_f32 v92, v92, v31
    v_cvt_pk_bf16_f32 v92, v92, v92
    v_lshlrev_b32 v92, 16, v92
    v_cvt_pk_bf16_f32 v93, v93, v93
    v_lshlrev_b32 v93, 16, v93
    v_and_b32 v31, 0xffff0000, v134
    v_add_f32 v93, v93, v31
    v_cvt_pk_bf16_f32 v93, v93, v93
    v_lshlrev_b32 v93, 16, v93
    v_mul_f32 v31, v93, v93
    v_mul_f32 v31, v31, v93
    v_mul_f32 v31, 0x3d372713, v31
    v_add_f32 v31, v31, v93
    v_mul_f32 v31, 0xc0135761, v31
    v_exp_f32 v31, v31
    s_nop 0
    v_add_f32 v31, 1.0, v31
    v_rcp_f32 v31, v31
    s_nop 0
    v_mul_f32 v93, v93, v31
    v_cvt_pk_bf16_f32 v93, v93, v93
    v_lshlrev_b32 v93, 16, v93
    v_cvt_pk_bf16_f32 v94, v94, v94
    v_lshlrev_b32 v94, 16, v94
    v_lshlrev_b32 v31, 16, v135
    v_add_f32 v94, v94, v31
    v_cvt_pk_bf16_f32 v94, v94, v94
    v_lshlrev_b32 v94, 16, v94
    v_mul_f32 v31, v94, v94
    v_mul_f32 v31, v31, v94
    v_mul_f32 v31, 0x3d372713, v31
    v_add_f32 v31, v31, v94
    v_mul_f32 v31, 0xc0135761, v31
    v_exp_f32 v31, v31
    s_nop 0
    v_add_f32 v31, 1.0, v31
    v_rcp_f32 v31, v31
    s_nop 0
    v_mul_f32 v94, v94, v31
    v_cvt_pk_bf16_f32 v94, v94, v94
    v_lshlrev_b32 v94, 16, v94
    v_cvt_pk_bf16_f32 v95, v95, v95
    v_lshlrev_b32 v95, 16, v95
    v_and_b32 v31, 0xffff0000, v135
    v_add_f32 v95, v95, v31
    v_cvt_pk_bf16_f32 v95, v95, v95
    v_lshlrev_b32 v95, 16, v95
    v_mul_f32 v31, v95, v95
    v_mul_f32 v31, v31, v95
    v_mul_f32 v31, 0x3d372713, v31
    v_add_f32 v31, v31, v95
    v_mul_f32 v31, 0xc0135761, v31
    v_exp_f32 v31, v31
    s_nop 0
    v_add_f32 v31, 1.0, v31
    v_rcp_f32 v31, v31
    s_nop 0
    v_mul_f32 v95, v95, v31
    v_cvt_pk_bf16_f32 v95, v95, v95
    v_lshlrev_b32 v95, 16, v95
    v_cvt_pk_bf16_f32 v38, v92, v93
    v_cvt_pk_bf16_f32 v39, v94, v95
    buffer_store_dwordx2 v[38:39], v30, s[12:15], 0 offen offset:48
    s_nop 1
    v_cvt_pk_bf16_f32 v112, v112, v112
    v_lshlrev_b32 v112, 16, v112
    v_lshlrev_b32 v31, 16, v136
    v_add_f32 v112, v112, v31
    v_cvt_pk_bf16_f32 v112, v112, v112
    v_lshlrev_b32 v112, 16, v112
    v_mul_f32 v31, v112, v112
    v_mul_f32 v31, v31, v112
    v_mul_f32 v31, 0x3d372713, v31
    v_add_f32 v31, v31, v112
    v_mul_f32 v31, 0xc0135761, v31
    v_exp_f32 v31, v31
    s_nop 0
    v_add_f32 v31, 1.0, v31
    v_rcp_f32 v31, v31
    s_nop 0
    v_mul_f32 v112, v112, v31
    v_cvt_pk_bf16_f32 v112, v112, v112
    v_lshlrev_b32 v112, 16, v112
    v_cvt_pk_bf16_f32 v113, v113, v113
    v_lshlrev_b32 v113, 16, v113
    v_and_b32 v31, 0xffff0000, v136
    v_add_f32 v113, v113, v31
    v_cvt_pk_bf16_f32 v113, v113, v113
    v_lshlrev_b32 v113, 16, v113
    v_mul_f32 v31, v113, v113
    v_mul_f32 v31, v31, v113
    v_mul_f32 v31, 0x3d372713, v31
    v_add_f32 v31, v31, v113
    v_mul_f32 v31, 0xc0135761, v31
    v_exp_f32 v31, v31
    s_nop 0
    v_add_f32 v31, 1.0, v31
    v_rcp_f32 v31, v31
    s_nop 0
    v_mul_f32 v113, v113, v31
    v_cvt_pk_bf16_f32 v113, v113, v113
    v_lshlrev_b32 v113, 16, v113
    v_cvt_pk_bf16_f32 v114, v114, v114
    v_lshlrev_b32 v114, 16, v114
    v_lshlrev_b32 v31, 16, v137
    v_add_f32 v114, v114, v31
    v_cvt_pk_bf16_f32 v114, v114, v114
    v_lshlrev_b32 v114, 16, v114
    v_mul_f32 v31, v114, v114
    v_mul_f32 v31, v31, v114
    v_mul_f32 v31, 0x3d372713, v31
    v_add_f32 v31, v31, v114
    v_mul_f32 v31, 0xc0135761, v31
    v_exp_f32 v31, v31
    s_nop 0
    v_add_f32 v31, 1.0, v31
    v_rcp_f32 v31, v31
    s_nop 0
    v_mul_f32 v114, v114, v31
    v_cvt_pk_bf16_f32 v114, v114, v114
    v_lshlrev_b32 v114, 16, v114
    v_cvt_pk_bf16_f32 v115, v115, v115
    v_lshlrev_b32 v115, 16, v115
    v_and_b32 v31, 0xffff0000, v137
    v_add_f32 v115, v115, v31
    v_cvt_pk_bf16_f32 v115, v115, v115
    v_lshlrev_b32 v115, 16, v115
    v_mul_f32 v31, v115, v115
    v_mul_f32 v31, v31, v115
    v_mul_f32 v31, 0x3d372713, v31
    v_add_f32 v31, v31, v115
    v_mul_f32 v31, 0xc0135761, v31
    v_exp_f32 v31, v31
    s_nop 0
    v_add_f32 v31, 1.0, v31
    v_rcp_f32 v31, v31
    s_nop 0
    v_mul_f32 v115, v115, v31
    v_cvt_pk_bf16_f32 v115, v115, v115
    v_lshlrev_b32 v115, 16, v115
    v_cvt_pk_bf16_f32 v32, v112, v113
    v_cvt_pk_bf16_f32 v33, v114, v115
    buffer_store_dwordx2 v[32:33], v30, s[12:15], 0 offen offset:64
    v_cvt_pk_bf16_f32 v116, v116, v116
    v_lshlrev_b32 v116, 16, v116
    v_lshlrev_b32 v31, 16, v138
    v_add_f32 v116, v116, v31
    v_cvt_pk_bf16_f32 v116, v116, v116
    v_lshlrev_b32 v116, 16, v116
    v_mul_f32 v31, v116, v116
    v_mul_f32 v31, v31, v116
    v_mul_f32 v31, 0x3d372713, v31
    v_add_f32 v31, v31, v116
    v_mul_f32 v31, 0xc0135761, v31
    v_exp_f32 v31, v31
    s_nop 0
    v_add_f32 v31, 1.0, v31
    v_rcp_f32 v31, v31
    s_nop 0
    v_mul_f32 v116, v116, v31
    v_cvt_pk_bf16_f32 v116, v116, v116
    v_lshlrev_b32 v116, 16, v116
    v_cvt_pk_bf16_f32 v117, v117, v117
    v_lshlrev_b32 v117, 16, v117
    v_and_b32 v31, 0xffff0000, v138
    v_add_f32 v117, v117, v31
    v_cvt_pk_bf16_f32 v117, v117, v117
    v_lshlrev_b32 v117, 16, v117
    v_mul_f32 v31, v117, v117
    v_mul_f32 v31, v31, v117
    v_mul_f32 v31, 0x3d372713, v31
    v_add_f32 v31, v31, v117
    v_mul_f32 v31, 0xc0135761, v31
    v_exp_f32 v31, v31
    s_nop 0
    v_add_f32 v31, 1.0, v31
    v_rcp_f32 v31, v31
    s_nop 0
    v_mul_f32 v117, v117, v31
    v_cvt_pk_bf16_f32 v117, v117, v117
    v_lshlrev_b32 v117, 16, v117
    v_cvt_pk_bf16_f32 v118, v118, v118
    v_lshlrev_b32 v118, 16, v118
    v_lshlrev_b32 v31, 16, v139
    v_add_f32 v118, v118, v31
    v_cvt_pk_bf16_f32 v118, v118, v118
    v_lshlrev_b32 v118, 16, v118
    v_mul_f32 v31, v118, v118
    v_mul_f32 v31, v31, v118
    v_mul_f32 v31, 0x3d372713, v31
    v_add_f32 v31, v31, v118
    v_mul_f32 v31, 0xc0135761, v31
    v_exp_f32 v31, v31
    s_nop 0
    v_add_f32 v31, 1.0, v31
    v_rcp_f32 v31, v31
    s_nop 0
    v_mul_f32 v118, v118, v31
    v_cvt_pk_bf16_f32 v118, v118, v118
    v_lshlrev_b32 v118, 16, v118
    v_cvt_pk_bf16_f32 v119, v119, v119
    v_lshlrev_b32 v119, 16, v119
    v_and_b32 v31, 0xffff0000, v139
    v_add_f32 v119, v119, v31
    v_cvt_pk_bf16_f32 v119, v119, v119
    v_lshlrev_b32 v119, 16, v119
    v_mul_f32 v31, v119, v119
    v_mul_f32 v31, v31, v119
    v_mul_f32 v31, 0x3d372713, v31
    v_add_f32 v31, v31, v119
    v_mul_f32 v31, 0xc0135761, v31
    v_exp_f32 v31, v31
    s_nop 0
    v_add_f32 v31, 1.0, v31
    v_rcp_f32 v31, v31
    s_nop 0
    v_mul_f32 v119, v119, v31
    v_cvt_pk_bf16_f32 v119, v119, v119
    v_lshlrev_b32 v119, 16, v119
    v_cvt_pk_bf16_f32 v34, v116, v117
    v_cvt_pk_bf16_f32 v35, v118, v119
    buffer_store_dwordx2 v[34:35], v30, s[12:15], 0 offen offset:80
    v_cvt_pk_bf16_f32 v120, v120, v120
    v_lshlrev_b32 v120, 16, v120
    v_lshlrev_b32 v31, 16, v140
    v_add_f32 v120, v120, v31
    v_cvt_pk_bf16_f32 v120, v120, v120
    v_lshlrev_b32 v120, 16, v120
    v_mul_f32 v31, v120, v120
    v_mul_f32 v31, v31, v120
    v_mul_f32 v31, 0x3d372713, v31
    v_add_f32 v31, v31, v120
    v_mul_f32 v31, 0xc0135761, v31
    v_exp_f32 v31, v31
    s_nop 0
    v_add_f32 v31, 1.0, v31
    v_rcp_f32 v31, v31
    s_nop 0
    v_mul_f32 v120, v120, v31
    v_cvt_pk_bf16_f32 v120, v120, v120
    v_lshlrev_b32 v120, 16, v120
    v_cvt_pk_bf16_f32 v121, v121, v121
    v_lshlrev_b32 v121, 16, v121
    v_and_b32 v31, 0xffff0000, v140
    v_add_f32 v121, v121, v31
    v_cvt_pk_bf16_f32 v121, v121, v121
    v_lshlrev_b32 v121, 16, v121
    v_mul_f32 v31, v121, v121
    v_mul_f32 v31, v31, v121
    v_mul_f32 v31, 0x3d372713, v31
    v_add_f32 v31, v31, v121
    v_mul_f32 v31, 0xc0135761, v31
    v_exp_f32 v31, v31
    s_nop 0
    v_add_f32 v31, 1.0, v31
    v_rcp_f32 v31, v31
    s_nop 0
    v_mul_f32 v121, v121, v31
    v_cvt_pk_bf16_f32 v121, v121, v121
    v_lshlrev_b32 v121, 16, v121
    v_cvt_pk_bf16_f32 v122, v122, v122
    v_lshlrev_b32 v122, 16, v122
    v_lshlrev_b32 v31, 16, v141
    v_add_f32 v122, v122, v31
    v_cvt_pk_bf16_f32 v122, v122, v122
    v_lshlrev_b32 v122, 16, v122
    v_mul_f32 v31, v122, v122
    v_mul_f32 v31, v31, v122
    v_mul_f32 v31, 0x3d372713, v31
    v_add_f32 v31, v31, v122
    v_mul_f32 v31, 0xc0135761, v31
    v_exp_f32 v31, v31
    s_nop 0
    v_add_f32 v31, 1.0, v31
    v_rcp_f32 v31, v31
    s_nop 0
    v_mul_f32 v122, v122, v31
    v_cvt_pk_bf16_f32 v122, v122, v122
    v_lshlrev_b32 v122, 16, v122
    v_cvt_pk_bf16_f32 v123, v123, v123
    v_lshlrev_b32 v123, 16, v123
    v_and_b32 v31, 0xffff0000, v141
    v_add_f32 v123, v123, v31
    v_cvt_pk_bf16_f32 v123, v123, v123
    v_lshlrev_b32 v123, 16, v123
    v_mul_f32 v31, v123, v123
    v_mul_f32 v31, v31, v123
    v_mul_f32 v31, 0x3d372713, v31
    v_add_f32 v31, v31, v123
    v_mul_f32 v31, 0xc0135761, v31
    v_exp_f32 v31, v31
    s_nop 0
    v_add_f32 v31, 1.0, v31
    v_rcp_f32 v31, v31
    s_nop 0
    v_mul_f32 v123, v123, v31
    v_cvt_pk_bf16_f32 v123, v123, v123
    v_lshlrev_b32 v123, 16, v123
    v_cvt_pk_bf16_f32 v36, v120, v121
    v_cvt_pk_bf16_f32 v37, v122, v123
    buffer_store_dwordx2 v[36:37], v30, s[12:15], 0 offen offset:96
    v_cvt_pk_bf16_f32 v124, v124, v124
    v_lshlrev_b32 v124, 16, v124
    v_lshlrev_b32 v31, 16, v142
    v_add_f32 v124, v124, v31
    v_cvt_pk_bf16_f32 v124, v124, v124
    v_lshlrev_b32 v124, 16, v124
    v_mul_f32 v31, v124, v124
    v_mul_f32 v31, v31, v124
    v_mul_f32 v31, 0x3d372713, v31
    v_add_f32 v31, v31, v124
    v_mul_f32 v31, 0xc0135761, v31
    v_exp_f32 v31, v31
    s_nop 0
    v_add_f32 v31, 1.0, v31
    v_rcp_f32 v31, v31
    s_nop 0
    v_mul_f32 v124, v124, v31
    v_cvt_pk_bf16_f32 v124, v124, v124
    v_lshlrev_b32 v124, 16, v124
    v_cvt_pk_bf16_f32 v125, v125, v125
    v_lshlrev_b32 v125, 16, v125
    v_and_b32 v31, 0xffff0000, v142
    v_add_f32 v125, v125, v31
    v_cvt_pk_bf16_f32 v125, v125, v125
    v_lshlrev_b32 v125, 16, v125
    v_mul_f32 v31, v125, v125
    v_mul_f32 v31, v31, v125
    v_mul_f32 v31, 0x3d372713, v31
    v_add_f32 v31, v31, v125
    v_mul_f32 v31, 0xc0135761, v31
    v_exp_f32 v31, v31
    s_nop 0
    v_add_f32 v31, 1.0, v31
    v_rcp_f32 v31, v31
    s_nop 0
    v_mul_f32 v125, v125, v31
    v_cvt_pk_bf16_f32 v125, v125, v125
    v_lshlrev_b32 v125, 16, v125
    v_cvt_pk_bf16_f32 v126, v126, v126
    v_lshlrev_b32 v126, 16, v126
    v_lshlrev_b32 v31, 16, v143
    v_add_f32 v126, v126, v31
    v_cvt_pk_bf16_f32 v126, v126, v126
    v_lshlrev_b32 v126, 16, v126
    v_mul_f32 v31, v126, v126
    v_mul_f32 v31, v31, v126
    v_mul_f32 v31, 0x3d372713, v31
    v_add_f32 v31, v31, v126
    v_mul_f32 v31, 0xc0135761, v31
    v_exp_f32 v31, v31
    s_nop 0
    v_add_f32 v31, 1.0, v31
    v_rcp_f32 v31, v31
    s_nop 0
    v_mul_f32 v126, v126, v31
    v_cvt_pk_bf16_f32 v126, v126, v126
    v_lshlrev_b32 v126, 16, v126
    v_cvt_pk_bf16_f32 v127, v127, v127
    v_lshlrev_b32 v127, 16, v127
    v_and_b32 v31, 0xffff0000, v143
    v_add_f32 v127, v127, v31
    v_cvt_pk_bf16_f32 v127, v127, v127
    v_lshlrev_b32 v127, 16, v127
    v_mul_f32 v31, v127, v127
    v_mul_f32 v31, v31, v127
    v_mul_f32 v31, 0x3d372713, v31
    v_add_f32 v31, v31, v127
    v_mul_f32 v31, 0xc0135761, v31
    v_exp_f32 v31, v31
    s_nop 0
    v_add_f32 v31, 1.0, v31
    v_rcp_f32 v31, v31
    s_nop 0
    v_mul_f32 v127, v127, v31
    v_cvt_pk_bf16_f32 v127, v127, v127
    v_lshlrev_b32 v127, 16, v127
    v_cvt_pk_bf16_f32 v38, v124, v125
    v_cvt_pk_bf16_f32 v39, v126, v127
    buffer_store_dwordx2 v[38:39], v30, s[12:15], 0 offen offset:112
    s_nop 1
    s_waitcnt vmcnt(0)
    s_endpgm
conv_7:
    s_sub_u32 s24, s2, 224
    s_movk_i32 s27, 4160
    s_mul_i32 s27, s27, s24
    s_add_u32 s27, s27, 0x400000
    s_lshl_b32 s28, s24, 12
    v_lshrrev_b32 v1, 6, v0
    v_and_b32 v2, 63, v0
    v_mov_b32 v8, 0
    v_mov_b32 v9, 0
    v_mov_b32 v10, 0
    v_mov_b32 v11, 0
    v_min_u32 v3, 159, v0
    v_lshlrev_b32 v3, 4, v3
    ds_write_b128 v3, v[8:11] offset:33280
    v_lshlrev_b32 v3, 4, v0
    v_add_u32 v3, s28, v3
    buffer_load_dwordx4 v[12:15], v3, s[12:15], 0 offen
    v_mov_b32 v4, v0
    s_nop 0
    v_lshlrev_b32 v5, 4, v4
    v_add_u32 v5, s27, v5
    v_subrev_u32 v7, 16, v5
    buffer_load_dwordx4 v[16:19], v7, s[12:15], 0 offen
    buffer_load_dwordx4 v[20:23], v5, s[12:15], 0 offen
    v_add_u32 v4, 256, v0
    v_min_u32 v4, 0x103, v4
    s_nop 0
    v_lshlrev_b32 v6, 4, v4
    v_add_u32 v6, s27, v6
    v_subrev_u32 v7, 16, v6
    buffer_load_dwordx4 v[24:27], v7, s[12:15], 0 offen
    buffer_load_dwordx4 v[28:31], v6, s[12:15], 0 offen
    v_lshrrev_b32 v3, 2, v0
    v_add_u32 v3, 32, v3
    s_movk_i32 s29, 80
    v_mul_lo_u32 v3, v3, s29
    v_and_b32 v4, 3, v0
    v_lshl_add_u32 v3, v4, 4, v3
    s_waitcnt vmcnt(0)
    ds_write_b128 v3, v[12:15] offset:33280
    v_mov_b32 v4, v0
    v_cmp_eq_u32 vcc, 0, v4
    s_nop 1
    v_cndmask_b32 v16, v16, 0, vcc
    v_cndmask_b32 v17, v17, 0, vcc
    v_cndmask_b32 v18, v18, 0, vcc
    v_cndmask_b32 v19, v19, 0, vcc
    v_lshlrev_b32 v4, 4, v4
    v_mov_b32 v40, v20
    v_mov_b32 v41, v21
    v_mov_b32 v42, v22
    v_mov_b32 v43, v23
    ds_write_b128 v4, v[40:43] offset:0
    s_nop 1
    v_alignbit_b32 v40, v20, v19, 16
    v_alignbit_b32 v41, v21, v20, 16
    v_alignbit_b32 v42, v22, v21, 16
    v_alignbit_b32 v43, v23, v22, 16
    ds_write_b128 v4, v[40:43] offset:4160
    s_nop 1
    v_mov_b32 v40, v19
    v_mov_b32 v41, v20
    v_mov_b32 v42, v21
    v_mov_b32 v43, v22
    ds_write_b128 v4, v[40:43] offset:8320
    s_nop 1
    v_alignbit_b32 v40, v19, v18, 16
    v_alignbit_b32 v41, v20, v19, 16
    v_alignbit_b32 v42, v21, v20, 16
    v_alignbit_b32 v43, v22, v21, 16
    ds_write_b128 v4, v[40:43] offset:12480
    s_nop 1
    v_mov_b32 v40, v18
    v_mov_b32 v41, v19
    v_mov_b32 v42, v20
    v_mov_b32 v43, v21
    ds_write_b128 v4, v[40:43] offset:16640
    s_nop 1
    v_alignbit_b32 v40, v18, v17, 16
    v_alignbit_b32 v41, v19, v18, 16
    v_alignbit_b32 v42, v20, v19, 16
    v_alignbit_b32 v43, v21, v20, 16
    ds_write_b128 v4, v[40:43] offset:20800
    s_nop 1
    v_mov_b32 v40, v17
    v_mov_b32 v41, v18
    v_mov_b32 v42, v19
    v_mov_b32 v43, v20
    ds_write_b128 v4, v[40:43] offset:24960
    s_nop 1
    v_alignbit_b32 v40, v17, v16, 16
    v_alignbit_b32 v41, v18, v17, 16
    v_alignbit_b32 v42, v19, v18, 16
    v_alignbit_b32 v43, v20, v19, 16
    ds_write_b128 v4, v[40:43] offset:29120
    s_nop 1
    v_add_u32 v4, 256, v0
    v_min_u32 v4, 0x103, v4
    v_cmp_eq_u32 vcc, 0, v4
    s_nop 1
    v_cndmask_b32 v24, v24, 0, vcc
    v_cndmask_b32 v25, v25, 0, vcc
    v_cndmask_b32 v26, v26, 0, vcc
    v_cndmask_b32 v27, v27, 0, vcc
    v_lshlrev_b32 v4, 4, v4
    v_mov_b32 v40, v28
    v_mov_b32 v41, v29
    v_mov_b32 v42, v30
    v_mov_b32 v43, v31
    ds_write_b128 v4, v[40:43] offset:0
    s_nop 1
    v_alignbit_b32 v40, v28, v27, 16
    v_alignbit_b32 v41, v29, v28, 16
    v_alignbit_b32 v42, v30, v29, 16
    v_alignbit_b32 v43, v31, v30, 16
    ds_write_b128 v4, v[40:43] offset:4160
    s_nop 1
    v_mov_b32 v40, v27
    v_mov_b32 v41, v28
    v_mov_b32 v42, v29
    v_mov_b32 v43, v30
    ds_write_b128 v4, v[40:43] offset:8320
    s_nop 1
    v_alignbit_b32 v40, v27, v26, 16
    v_alignbit_b32 v41, v28, v27, 16
    v_alignbit_b32 v42, v29, v28, 16
    v_alignbit_b32 v43, v30, v29, 16
    ds_write_b128 v4, v[40:43] offset:12480
    s_nop 1
    v_mov_b32 v40, v26
    v_mov_b32 v41, v27
    v_mov_b32 v42, v28
    v_mov_b32 v43, v29
    ds_write_b128 v4, v[40:43] offset:16640
    s_nop 1
    v_alignbit_b32 v40, v26, v25, 16
    v_alignbit_b32 v41, v27, v26, 16
    v_alignbit_b32 v42, v28, v27, 16
    v_alignbit_b32 v43, v29, v28, 16
    ds_write_b128 v4, v[40:43] offset:20800
    s_nop 1
    v_mov_b32 v40, v25
    v_mov_b32 v41, v26
    v_mov_b32 v42, v27
    v_mov_b32 v43, v28
    ds_write_b128 v4, v[40:43] offset:24960
    s_nop 1
    v_alignbit_b32 v40, v25, v24, 16
    v_alignbit_b32 v41, v26, v25, 16
    v_alignbit_b32 v42, v27, v26, 16
    v_alignbit_b32 v43, v28, v27, 16
    ds_write_b128 v4, v[40:43] offset:29120
    s_nop 1
    s_waitcnt lgkmcnt(0)
    s_barrier
    v_readfirstlane_b32 s30, v1
    s_nop 3
    s_cmp_eq_u32 s30, 3
    s_cbranch_scc1 cv_skip_8
    v_and_b32 v7, 31, v2
    v_lshrrev_b32 v8, 5, v2
    v_and_b32 v3, 7, v7
    v_mul_u32_u24 v3, 4160, v3
    v_and_b32 v4, 24, v7
    v_lshlrev_b32 v4, 1, v4
    v_sub_u32 v3, v3, v4
    v_lshl_add_u32 v3, v8, 4, v3
    s_lshr_b32 s31, s30, 1
    s_mul_i32 s32, s31, 2048
    s_sub_u32 s32, 2048, s32
    v_add_u32 v3, s32, v3
    s_min_u32 s33, s30, 1
    s_mul_i32 s33, s33, 32
    s_mul_i32 s34, s31, 32
    s_sub_u32 s33, s33, s34
    v_add_u32 v4, s33, v7
    v_mul_lo_u32 v4, v4, s29
    v_lshl_add_u32 v4, v8, 4, v4
    v_mov_b32 v64, 0
    v_mov_b32 v65, 0
    v_mov_b32 v66, 0
    v_mov_b32 v67, 0
    v_mov_b32 v68, 0
    v_mov_b32 v69, 0
    v_mov_b32 v70, 0
    v_mov_b32 v71, 0
    v_mov_b32 v72, 0
    v_mov_b32 v73, 0
    v_mov_b32 v74, 0
    v_mov_b32 v75, 0
    v_mov_b32 v76, 0
    v_mov_b32 v77, 0
    v_mov_b32 v78, 0
    v_mov_b32 v79, 0
    s_cmp_eq_u32 s30, 2
    s_cbranch_scc1 cv_m_9
    ds_read_b128 v[32:35], v3 offset:2080
    ds_read_b128 v[36:39], v4 offset:35872
    s_waitcnt lgkmcnt(0)
    v_mfma_f32_32x32x16_bf16 v[64:79], v[32:35], v[36:39], v[64:79]
cv_m_9:
    ds_read_b128 v[32:35], v3 offset:2048
    ds_read_b128 v[36:39], v4 offset:35840
    ds_read_b128 v[40:43], v3 offset:2016
    ds_read_b128 v[44:47], v4 offset:35792
    ds_read_b128 v[48:51], v3 offset:1984
    ds_read_b128 v[52:55], v4 offset:35760
    ds_read_b128 v[56:59], v3 offset:1952
    ds_read_b128 v[60:63], v4 offset:35712
    s_waitcnt lgkmcnt(6)
    v_mfma_f32_32x32x16_bf16 v[64:79], v[32:35], v[36:39], v[64:79]
    ds_read_b128 v[32:35], v3 offset:1920
    ds_read_b128 v[36:39], v4 offset:35680
    s_waitcnt lgkmcnt(6)
    v_mfma_f32_32x32x16_bf16 v[64:79], v[40:43], v[44:47], v[64:79]
    ds_read_b128 v[40:43], v3 offset:1888
    ds_read_b128 v[44:47], v4 offset:35632
    s_waitcnt lgkmcnt(6)
    v_mfma_f32_32x32x16_bf16 v[64:79], v[48:51], v[52:55], v[64:79]
    ds_read_b128 v[48:51], v3 offset:1856
    ds_read_b128 v[52:55], v4 offset:35600
    s_waitcnt lgkmcnt(6)
    v_mfma_f32_32x32x16_bf16 v[64:79], v[56:59], v[60:63], v[64:79]
    ds_read_b128 v[56:59], v3 offset:1824
    ds_read_b128 v[60:63], v4 offset:35552
    s_waitcnt lgkmcnt(6)
    v_mfma_f32_32x32x16_bf16 v[64:79], v[32:35], v[36:39], v[64:79]
    ds_read_b128 v[32:35], v3 offset:1792
    ds_read_b128 v[36:39], v4 offset:35520
    s_waitcnt lgkmcnt(6)
    v_mfma_f32_32x32x16_bf16 v[64:79], v[40:43], v[44:47], v[64:79]
    ds_read_b128 v[40:43], v3 offset:1760
    ds_read_b128 v[44:47], v4 offset:35472
    s_waitcnt lgkmcnt(6)
    v_mfma_f32_32x32x16_bf16 v[64:79], v[48:51], v[52:55], v[64:79]
    ds_read_b128 v[48:51], v3 offset:1728
    ds_read_b128 v[52:55], v4 offset:35440
    s_waitcnt lgkmcnt(6)
    v_mfma_f32_32x32x16_bf16 v[64:79], v[56:59], v[60:63], v[64:79]
    ds_read_b128 v[56:59], v3 offset:1696
    ds_read_b128 v[60:63], v4 offset:35392
    s_waitcnt lgkmcnt(6)
    v_mfma_f32_32x32x16_bf16 v[64:79], v[32:35], v[36:39], v[64:79]
    ds_read_b128 v[32:35], v3 offset:1664
    ds_read_b128 v[36:39], v4 offset:35360
    s_waitcnt lgkmcnt(6)
    v_mfma_f32_32x32x16_bf16 v[64:79], v[40:43], v[44:47], v[64:79]
    ds_read_b128 v[40:43], v3 offset:1632
    ds_read_b128 v[44:47], v4 offset:35312
    s_waitcnt lgkmcnt(6)
    v_mfma_f32_32x32x16_bf16 v[64:79], v[48:51], v[52:55], v[64:79]
    ds_read_b128 v[48:51], v3 offset:1600
    ds_read_b128 v[52:55], v4 offset:35280
    s_waitcnt lgkmcnt(6)
    v_mfma_f32_32x32x16_bf16 v[64:79], v[56:59], v[60:63], v[64:79]
    ds_read_b128 v[56:59], v3 offset:1568
    ds_read_b128 v[60:63], v4 offset:35232
    s_waitcnt lgkmcnt(6)
    v_mfma_f32_32x32x16_bf16 v[64:79], v[32:35], v[36:39], v[64:79]
    ds_read_b128 v[32:35], v3 offset:1536
    ds_read_b128 v[36:39], v4 offset:35200
    s_waitcnt lgkmcnt(6)
    v_mfma_f32_32x32x16_bf16 v[64:79], v[40:43], v[44:47], v[64:79]
    ds_read_b128 v[40:43], v3 offset:1504
    ds_read_b128 v[44:47], v4 offset:35152
    s_waitcnt lgkmcnt(6)
    v_mfma_f32_32x32x16_bf16 v[64:79], v[48:51], v[52:55], v[64:79]
    ds_read_b128 v[48:51], v3 offset:1472
    ds_read_b128 v[52:55], v4 offset:35120
    s_waitcnt lgkmcnt(6)
    v_mfma_f32_32x32x16_bf16 v[64:79], v[56:59], v[60:63], v[64:79]
    ds_read_b128 v[56:59], v3 offset:1440
    ds_read_b128 v[60:63], v4 offset:35072
    s_waitcnt lgkmcnt(6)
    v_mfma_f32_32x32x16_bf16 v[64:79], v[32:35], v[36:39], v[64:79]
    ds_read_b128 v[32:35], v3 offset:1408
    ds_read_b128 v[36:39], v4 offset:35040
    s_waitcnt lgkmcnt(6)
    v_mfma_f32_32x32x16_bf16 v[64:79], v[40:43], v[44:47], v[64:79]
    ds_read_b128 v[40:43], v3 offset:1376
    ds_read_b128 v[44:47], v4 offset:34992
    s_waitcnt lgkmcnt(6)
    v_mfma_f32_32x32x16_bf16 v[64:79], v[48:51], v[52:55], v[64:79]
    ds_read_b128 v[48:51], v3 offset:1344
    ds_read_b128 v[52:55], v4 offset:34960
    s_waitcnt lgkmcnt(6)
    v_mfma_f32_32x32x16_bf16 v[64:79], v[56:59], v[60:63], v[64:79]
    ds_read_b128 v[56:59], v3 offset:1312
    ds_read_b128 v[60:63], v4 offset:34912
    s_waitcnt lgkmcnt(6)
    v_mfma_f32_32x32x16_bf16 v[64:79], v[32:35], v[36:39], v[64:79]
    ds_read_b128 v[32:35], v3 offset:1280
    ds_read_b128 v[36:39], v4 offset:34880
    s_waitcnt lgkmcnt(6)
    v_mfma_f32_32x32x16_bf16 v[64:79], v[40:43], v[44:47], v[64:79]
    ds_read_b128 v[40:43], v3 offset:1248
    ds_read_b128 v[44:47], v4 offset:34832
    s_waitcnt lgkmcnt(6)
    v_mfma_f32_32x32x16_bf16 v[64:79], v[48:51], v[52:55], v[64:79]
    ds_read_b128 v[48:51], v3 offset:1216
    ds_read_b128 v[52:55], v4 offset:34800
    s_waitcnt lgkmcnt(6)
    v_mfma_f32_32x32x16_bf16 v[64:79], v[56:59], v[60:63], v[64:79]
    ds_read_b128 v[56:59], v3 offset:1184
    ds_read_b128 v[60:63], v4 offset:34752
    s_waitcnt lgkmcnt(6)
    v_mfma_f32_32x32x16_bf16 v[64:79], v[32:35], v[36:39], v[64:79]
    ds_read_b128 v[32:35], v3 offset:1152
    ds_read_b128 v[36:39], v4 offset:34720
    s_waitcnt lgkmcnt(6)
    v_mfma_f32_32x32x16_bf16 v[64:79], v[40:43], v[44:47], v[64:79]
    ds_read_b128 v[40:43], v3 offset:1120
    ds_read_b128 v[44:47], v4 offset:34672
    s_waitcnt lgkmcnt(6)
    v_mfma_f32_32x32x16_bf16 v[64:79], v[48:51], v[52:55], v[64:79]
    ds_read_b128 v[48:51], v3 offset:1088
    ds_read_b128 v[52:55], v4 offset:34640
    s_waitcnt lgkmcnt(6)
    v_mfma_f32_32x32x16_bf16 v[64:79], v[56:59], v[60:63], v[64:79]
    ds_read_b128 v[56:59], v3 offset:1056
    ds_read_b128 v[60:63], v4 offset:34592
    s_waitcnt lgkmcnt(6)
    v_mfma_f32_32x32x16_bf16 v[64:79], v[32:35], v[36:39], v[64:79]
    ds_read_b128 v[32:35], v3 offset:1024
    ds_read_b128 v[36:39], v4 offset:34560
    s_waitcnt lgkmcnt(6)
    v_mfma_f32_32x32x16_bf16 v[64:79], v[40:43], v[44:47], v[64:79]
    ds_read_b128 v[40:43], v3 offset:992
    ds_read_b128 v[44:47], v4 offset:34512
    s_waitcnt lgkmcnt(6)
    v_mfma_f32_32x32x16_bf16 v[64:79], v[48:51], v[52:55], v[64:79]
    ds_read_b128 v[48:51], v3 offset:960
    ds_read_b128 v[52:55], v4 offset:34480
    s_waitcnt lgkmcnt(6)
    v_mfma_f32_32x32x16_bf16 v[64:79], v[56:59], v[60:63], v[64:79]
    ds_read_b128 v[56:59], v3 offset:928
    ds_read_b128 v[60:63], v4 offset:34432
    s_waitcnt lgkmcnt(6)
    v_mfma_f32_32x32x16_bf16 v[64:79], v[32:35], v[36:39], v[64:79]
    ds_read_b128 v[32:35], v3 offset:896
    ds_read_b128 v[36:39], v4 offset:34400
    s_waitcnt lgkmcnt(6)
    v_mfma_f32_32x32x16_bf16 v[64:79], v[40:43], v[44:47], v[64:79]
    ds_read_b128 v[40:43], v3 offset:864
    ds_read_b128 v[44:47], v4 offset:34352
    s_waitcnt lgkmcnt(6)
    v_mfma_f32_32x32x16_bf16 v[64:79], v[48:51], v[52:55], v[64:79]
    ds_read_b128 v[48:51], v3 offset:832
    ds_read_b128 v[52:55], v4 offset:34320
    s_waitcnt lgkmcnt(6)
    v_mfma_f32_32x32x16_bf16 v[64:79], v[56:59], v[60:63], v[64:79]
    ds_read_b128 v[56:59], v3 offset:800
    ds_read_b128 v[60:63], v4 offset:34272
    s_waitcnt lgkmcnt(6)
    v_mfma_f32_32x32x16_bf16 v[64:79], v[32:35], v[36:39], v[64:79]
    ds_read_b128 v[32:35], v3 offset:768
    ds_read_b128 v[36:39], v4 offset:34240
    s_waitcnt lgkmcnt(6)
    v_mfma_f32_32x32x16_bf16 v[64:79], v[40:43], v[44:47], v[64:79]
    ds_read_b128 v[40:43], v3 offset:736
    ds_read_b128 v[44:47], v4 offset:34192
    s_waitcnt lgkmcnt(6)
    v_mfma_f32_32x32x16_bf16 v[64:79], v[48:51], v[52:55], v[64:79]
    ds_read_b128 v[48:51], v3 offset:704
    ds_read_b128 v[52:55], v4 offset:34160
    s_waitcnt lgkmcnt(6)
    v_mfma_f32_32x32x16_bf16 v[64:79], v[56:59], v[60:63], v[64:79]
    ds_read_b128 v[56:59], v3 offset:672
    ds_read_b128 v[60:63], v4 offset:34112
    s_waitcnt lgkmcnt(6)
    v_mfma_f32_32x32x16_bf16 v[64:79], v[32:35], v[36:39], v[64:79]
    ds_read_b128 v[32:35], v3 offset:640
    ds_read_b128 v[36:39], v4 offset:34080
    s_waitcnt lgkmcnt(6)
    v_mfma_f32_32x32x16_bf16 v[64:79], v[40:43], v[44:47], v[64:79]
    ds_read_b128 v[40:43], v3 offset:608
    ds_read_b128 v[44:47], v4 offset:34032
    s_waitcnt lgkmcnt(6)
    v_mfma_f32_32x32x16_bf16 v[64:79], v[48:51], v[52:55], v[64:79]
    ds_read_b128 v[48:51], v3 offset:576
    ds_read_b128 v[52:55], v4 offset:34000
    s_waitcnt lgkmcnt(6)
    v_mfma_f32_32x32x16_bf16 v[64:79], v[56:59], v[60:63], v[64:79]
    ds_read_b128 v[56:59], v3 offset:544
    ds_read_b128 v[60:63], v4 offset:33952
    s_waitcnt lgkmcnt(6)
    v_mfma_f32_32x32x16_bf16 v[64:79], v[32:35], v[36:39], v[64:79]
    ds_read_b128 v[32:35], v3 offset:512
    ds_read_b128 v[36:39], v4 offset:33920
    s_waitcnt lgkmcnt(6)
    v_mfma_f32_32x32x16_bf16 v[64:79], v[40:43], v[44:47], v[64:79]
    ds_read_b128 v[40:43], v3 offset:480
    ds_read_b128 v[44:47], v4 offset:33872
    s_waitcnt lgkmcnt(6)
    v_mfma_f32_32x32x16_bf16 v[64:79], v[48:51], v[52:55], v[64:79]
    ds_read_b128 v[48:51], v3 offset:448
    ds_read_b128 v[52:55], v4 offset:33840
    s_waitcnt lgkmcnt(6)
    v_mfma_f32_32x32x16_bf16 v[64:79], v[56:59], v[60:63], v[64:79]
    ds_read_b128 v[56:59], v3 offset:416
    ds_read_b128 v[60:63], v4 offset:33792
    s_waitcnt lgkmcnt(6)
    v_mfma_f32_32x32x16_bf16 v[64:79], v[32:35], v[36:39], v[64:79]
    ds_read_b128 v[32:35], v3 offset:384
    ds_read_b128 v[36:39], v4 offset:33760
    s_waitcnt lgkmcnt(6)
    v_mfma_f32_32x32x16_bf16 v[64:79], v[40:43], v[44:47], v[64:79]
    ds_read_b128 v[40:43], v3 offset:352
    ds_read_b128 v[44:47], v4 offset:33712
    s_waitcnt lgkmcnt(6)
    v_mfma_f32_32x32x16_bf16 v[64:79], v[48:51], v[52:55], v[64:79]
    ds_read_b128 v[48:51], v3 offset:320
    ds_read_b128 v[52:55], v4 offset:33680
    s_waitcnt lgkmcnt(6)
    v_mfma_f32_32x32x16_bf16 v[64:79], v[56:59], v[60:63], v[64:79]
    ds_read_b128 v[56:59], v3 offset:288
    ds_read_b128 v[60:63], v4 offset:33632
    s_waitcnt lgkmcnt(6)
    v_mfma_f32_32x32x16_bf16 v[64:79], v[32:35], v[36:39], v[64:79]
    ds_read_b128 v[32:35], v3 offset:256
    ds_read_b128 v[36:39], v4 offset:33600
    s_waitcnt lgkmcnt(6)
    v_mfma_f32_32x32x16_bf16 v[64:79], v[40:43], v[44:47], v[64:79]
    ds_read_b128 v[40:43], v3 offset:224
    ds_read_b128 v[44:47], v4 offset:33552
    s_waitcnt lgkmcnt(6)
    v_mfma_f32_32x32x16_bf16 v[64:79], v[48:51], v[52:55], v[64:79]
    ds_read_b128 v[48:51], v3 offset:192
    ds_read_b128 v[52:55], v4 offset:33520
    s_waitcnt lgkmcnt(6)
    v_mfma_f32_32x32x16_bf16 v[64:79], v[56:59], v[60:63], v[64:79]
    ds_read_b128 v[56:59], v3 offset:160
    ds_read_b128 v[60:63], v4 offset:33472
    s_waitcnt lgkmcnt(6)
    v_mfma_f32_32x32x16_bf16 v[64:79], v[32:35], v[36:39], v[64:79]
    ds_read_b128 v[32:35], v3 offset:128
    ds_read_b128 v[36:39], v4 offset:33440
    s_waitcnt lgkmcnt(6)
    v_mfma_f32_32x32x16_bf16 v[64:79], v[40:43], v[44:47], v[64:79]
    ds_read_b128 v[40:43], v3 offset:96
    ds_read_b128 v[44:47], v4 offset:33392
    s_waitcnt lgkmcnt(6)
    v_mfma_f32_32x32x16_bf16 v[64:79], v[48:51], v[52:55], v[64:79]
    ds_read_b128 v[48:51], v3 offset:64
    ds_read_b128 v[52:55], v4 offset:33360
    s_waitcnt lgkmcnt(6)
    v_mfma_f32_32x32x16_bf16 v[64:79], v[56:59], v[60:63], v[64:79]
    ds_read_b128 v[56:59], v3 offset:32
    ds_read_b128 v[60:63], v4 offset:33312
    s_waitcnt lgkmcnt(6)
    v_mfma_f32_32x32x16_bf16 v[64:79], v[32:35], v[36:39], v[64:79]
    s_waitcnt lgkmcnt(4)
    v_mfma_f32_32x32x16_bf16 v[64:79], v[40:43], v[44:47], v[64:79]
    s_waitcnt lgkmcnt(2)
    v_mfma_f32_32x32x16_bf16 v[64:79], v[48:51], v[52:55], v[64:79]
    s_cmp_eq_u32 s30, 2
    s_cbranch_scc1 cv_l_10
    s_waitcnt lgkmcnt(0)
    v_mfma_f32_32x32x16_bf16 v[64:79], v[56:59], v[60:63], v[64:79]
cv_l_10:
    s_waitcnt lgkmcnt(0)
    s_nop 7
    s_nop 7
    v_lshlrev_b32 v5, 7, v7
    v_lshl_add_u32 v5, v8, 4, v5
    v_lshl_add_u32 v5, v1, 12, v5
    ds_write_b128 v5, v[64:67] offset:40960
    ds_write_b128 v5, v[68:71] offset:40992
    ds_write_b128 v5, v[72:75] offset:41024
    ds_write_b128 v5, v[76:79] offset:41056
cv_skip_8:
    s_waitcnt lgkmcnt(0)
    s_barrier
    s_load_dwordx2 s[4:5], s[0:1], 64
    s_lshl_b32 s6, s24, 1
    v_mov_b32 v9, s6
    s_waitcnt lgkmcnt(0)
    global_load_ushort v9, v9, s[4:5]
    v_lshlrev_b32 v3, 5, v0
    v_cmp_lt_u32 vcc, 0x7f, v0
    v_mov_b32 v6, 0x1000
    s_nop 1
    v_cndmask_b32 v6, 0, v6, vcc
    ds_read_b128 v[16:19], v3 offset:40960
    ds_read_b128 v[20:23], v3 offset:40976
    v_add_u32 v7, v3, v6
    ds_read_b128 v[24:27], v7 offset:40960
    ds_read_b128 v[28:31], v7 offset:40976
    v_lshrrev_b32 v4, 2, v0
    v_add_u32 v4, 32, v4
    v_mul_lo_u32 v4, v4, s29
    v_and_b32 v5, 3, v0
    v_lshl_add_u32 v4, v5, 4, v4
    ds_read_b128 v[12:15], v4 offset:33280
    v_cndmask_b32 v8, 0, 1.0, vcc
    s_waitcnt vmcnt(0) lgkmcnt(0)
    v_lshlrev_b32 v9, 16, v9
    v_fma_f32 v16, v24, v8, v16
    v_cvt_pk_bf16_f32 v16, v16, v16
    v_lshlrev_b32 v16, 16, v16
    v_lshlrev_b32 v10, 16, v12
    v_mul_f32 v10, v10, v9
    v_cvt_pk_bf16_f32 v10, v10, v10
    v_lshlrev_b32 v10, 16, v10
    v_add_f32 v16, v16, v10
    v_fma_f32 v17, v25, v8, v17
    v_cvt_pk_bf16_f32 v17, v17, v17
    v_lshlrev_b32 v17, 16, v17
    v_and_b32 v10, 0xffff0000, v12
    v_mul_f32 v10, v10, v9
    v_cvt_pk_bf16_f32 v10, v10, v10
    v_lshlrev_b32 v10, 16, v10
    v_add_f32 v17, v17, v10
    v_fma_f32 v18, v26, v8, v18
    v_cvt_pk_bf16_f32 v18, v18, v18
    v_lshlrev_b32 v18, 16, v18
    v_lshlrev_b32 v10, 16, v13
    v_mul_f32 v10, v10, v9
    v_cvt_pk_bf16_f32 v10, v10, v10
    v_lshlrev_b32 v10, 16, v10
    v_add_f32 v18, v18, v10
    v_fma_f32 v19, v27, v8, v19
    v_cvt_pk_bf16_f32 v19, v19, v19
    v_lshlrev_b32 v19, 16, v19
    v_and_b32 v10, 0xffff0000, v13
    v_mul_f32 v10, v10, v9
    v_cvt_pk_bf16_f32 v10, v10, v10
    v_lshlrev_b32 v10, 16, v10
    v_add_f32 v19, v19, v10
    v_fma_f32 v20, v28, v8, v20
    v_cvt_pk_bf16_f32 v20, v20, v20
    v_lshlrev_b32 v20, 16, v20
    v_lshlrev_b32 v10, 16, v14
    v_mul_f32 v10, v10, v9
    v_cvt_pk_bf16_f32 v10, v10, v10
    v_lshlrev_b32 v10, 16, v10
    v_add_f32 v20, v20, v10
    v_fma_f32 v21, v29, v8, v21
    v_cvt_pk_bf16_f32 v21, v21, v21
    v_lshlrev_b32 v21, 16, v21
    v_and_b32 v10, 0xffff0000, v14
    v_mul_f32 v10, v10, v9
    v_cvt_pk_bf16_f32 v10, v10, v10
    v_lshlrev_b32 v10, 16, v10
    v_add_f32 v21, v21, v10
    v_fma_f32 v22, v30, v8, v22
    v_cvt_pk_bf16_f32 v22, v22, v22
    v_lshlrev_b32 v22, 16, v22
    v_lshlrev_b32 v10, 16, v15
    v_mul_f32 v10, v10, v9
    v_cvt_pk_bf16_f32 v10, v10, v10
    v_lshlrev_b32 v10, 16, v10
    v_add_f32 v22, v22, v10
    v_fma_f32 v23, v31, v8, v23
    v_cvt_pk_bf16_f32 v23, v23, v23
    v_lshlrev_b32 v23, 16, v23
    v_and_b32 v10, 0xffff0000, v15
    v_mul_f32 v10, v10, v9
    v_cvt_pk_bf16_f32 v10, v10, v10
    v_lshlrev_b32 v10, 16, v10
    v_add_f32 v23, v23, v10
    v_cvt_pk_bf16_f32 v40, v16, v17
    v_cvt_pk_bf16_f32 v41, v18, v19
    v_cvt_pk_bf16_f32 v42, v20, v21
    v_cvt_pk_bf16_f32 v43, v22, v23
    v_lshlrev_b32 v3, 4, v0
    v_add_u32 v3, s28, v3
    v_add_u32 v3, 0x10a0000, v3
    buffer_store_dwordx4 v[40:43], v3, s[12:15], 0 offen
    s_waitcnt vmcnt(0)
end_6:
    s_endpgm
.globl k3_kernel
.p2align 8
.type k3_kernel,@function
k3_kernel:
    s_cmp_ge_u32 s2, 256
    s_cbranch_scc1 end_11
    s_load_dwordx2 s[6:7], s[0:1], 128
    s_waitcnt lgkmcnt(0)
    s_mov_b32 s12, s6
    s_mov_b32 s13, s7
    s_mov_b32 s14, 268435456
    s_mov_b32 s15, 0x00020000
    s_lshr_b32 s44, s2, 5
    s_lshl_b32 s44, s44, 6
    s_and_b32 s45, s2, 31
    s_lshl_b32 s45, s45, 6
    v_lshrrev_b32 v1, 6, v0
    v_and_b32 v2, 63, v0
    v_readfirstlane_b32 s40, v1
    v_lshrrev_b32 v3, 3, v2
    v_lshl_add_u32 v3, v1, 3, v3
    v_lshrrev_b32 v4, 1, v3
    v_and_b32 v4, 7, v4
    v_and_b32 v5, 7, v2
    v_xor_b32 v4, v4, v5
    v_lshlrev_b32 v4, 4, v4
    v_add_u32 v5, s44, v3
    s_mov_b32 s41, 3584
    v_mul_lo_u32 v5, v5, s41
    v_add_u32 v5, v5, v4
    v_add_u32 v6, s45, v3
    s_mov_b32 s41, 3584
    v_mul_lo_u32 v6, v6, s41
    v_add_u32 v6, v6, v4
    v_and_b32 v7, 31, v2
    v_lshrrev_b32 v8, 5, v2
    v_lshrrev_b32 v9, 1, v7
    v_and_b32 v9, 7, v9
    v_and_b32 v10, 1, v1
    v_bfe_u32 v11, v1, 1, 1
    s_lshr_b32 s46, s40, 2
    v_add_u32 v12, 0, v8
    v_xor_b32 v12, v12, v9
    v_lshlrev_b32 v12, 4, v12
    v_lshl_add_u32 v12, v7, 7, v12
    v_mul_u32_u24 v13, 4096, v10
    v_add_u32 v16, v12, v13
    v_mul_u32_u24 v13, 4096, v11
    v_add_u32 v13, 8192, v13
    v_add_u32 v20, v12, v13
    v_add_u32 v12, 2, v8
    v_xor_b32 v12, v12, v9
    v_lshlrev_b32 v12, 4, v12
    v_lshl_add_u32 v12, v7, 7, v12
    v_mul_u32_u24 v13, 4096, v10
    v_add_u32 v17, v12, v13
    v_mul_u32_u24 v13, 4096, v11
    v_add_u32 v13, 8192, v13
    v_add_u32 v21, v12, v13
    v_add_u32 v12, 4, v8
    v_xor_b32 v12, v12, v9
    v_lshlrev_b32 v12, 4, v12
    v_lshl_add_u32 v12, v7, 7, v12
    v_mul_u32_u24 v13, 4096, v10
    v_add_u32 v18, v12, v13
    v_mul_u32_u24 v13, 4096, v11
    v_add_u32 v13, 8192, v13
    v_add_u32 v22, v12, v13
    v_add_u32 v12, 6, v8
    v_xor_b32 v12, v12, v9
    v_lshlrev_b32 v12, 4, v12
    v_lshl_add_u32 v12, v7, 7, v12
    v_mul_u32_u24 v13, 4096, v10
    v_add_u32 v19, v12, v13
    v_mul_u32_u24 v13, 4096, v11
    v_add_u32 v13, 8192, v13
    v_add_u32 v23, v12, v13
    v_mov_b32 v64, 0
    v_mov_b32 v65, 0
    v_mov_b32 v66, 0
    v_mov_b32 v67, 0
    v_mov_b32 v68, 0
    v_mov_b32 v69, 0
    v_mov_b32 v70, 0
    v_mov_b32 v71, 0
    v_mov_b32 v72, 0
    v_mov_b32 v73, 0
    v_mov_b32 v74, 0
    v_mov_b32 v75, 0
    v_mov_b32 v76, 0
    v_mov_b32 v77, 0
    v_mov_b32 v78, 0
    v_mov_b32 v79, 0
    s_load_dwordx2 s[4:5], s[0:1], 104
    s_load_dwordx2 s[6:7], s[0:1], 0
    s_load_dwordx2 s[20:21], s[0:1], 112
    s_waitcnt lgkmcnt(0)
    s_mov_b32 s16, s4
    s_mov_b32 s17, s5
    s_mov_b32 s18, 1024
    s_mov_b32 s19, 0x00020000
    s_mov_b32 s24, s6
    s_mov_b32 s25, s7
    s_mov_b32 s26, 2097152
    s_mov_b32 s27, 0x00020000
    s_mov_b32 s28, s20
    s_mov_b32 s29, s21
    s_mov_b32 s30, 2097152
    s_mov_b32 s31, 0x00020000
    v_lshlrev_b32 v12, 5, v10
    v_lshl_add_u32 v12, v8, 2, v12
    v_add_u32 v12, s44, v12
    v_lshlrev_b32 v13, 1, v12
    v_lshlrev_b32 v30, 5, v11
    v_add_u32 v30, v30, v7
    v_add_u32 v30, s45, v30
    v_lshl_add_u32 v14, v30, 10, v13
    v_lshlrev_b32 v15, 12, v12
    v_lshl_add_u32 v15, v30, 1, v15
    v_add_u32 v15, 0x10a0000, v15
    buffer_load_dwordx2 v[96:97], v13, s[16:19], 0 offen offset:0
    buffer_load_dwordx2 v[98:99], v14, s[24:27], 0 offen offset:0
    v_add_u32 v31, 0, v15
    buffer_load_ushort v100, v31, s[12:15], 0 offen
    v_add_u32 v31, 4096, v15
    buffer_load_ushort v101, v31, s[12:15], 0 offen
    v_add_u32 v31, 8192, v15
    buffer_load_ushort v102, v31, s[12:15], 0 offen
    v_add_u32 v31, 12288, v15
    buffer_load_ushort v103, v31, s[12:15], 0 offen
    buffer_load_dwordx2 v[104:105], v13, s[16:19], 0 offen offset:16
    buffer_load_dwordx2 v[106:107], v14, s[24:27], 0 offen offset:16
    v_add_u32 v31, 32768, v15
    buffer_load_ushort v108, v31, s[12:15], 0 offen
    v_add_u32 v31, 36864, v15
    buffer_load_ushort v109, v31, s[12:15], 0 offen
    v_add_u32 v31, 40960, v15
    buffer_load_ushort v110, v31, s[12:15], 0 offen
    v_add_u32 v31, 45056, v15
    buffer_load_ushort v111, v31, s[12:15], 0 offen
    buffer_load_dwordx2 v[112:113], v13, s[16:19], 0 offen offset:32
    buffer_load_dwordx2 v[114:115], v14, s[24:27], 0 offen offset:32
    v_add_u32 v31, 65536, v15
    buffer_load_ushort v116, v31, s[12:15], 0 offen
    v_add_u32 v31, 69632, v15
    buffer_load_ushort v117, v31, s[12:15], 0 offen
    v_add_u32 v31, 73728, v15
    buffer_load_ushort v118, v31, s[12:15], 0 offen
    v_add_u32 v31, 77824, v15
    buffer_load_ushort v119, v31, s[12:15], 0 offen
    buffer_load_dwordx2 v[120:121], v13, s[16:19], 0 offen offset:48
    buffer_load_dwordx2 v[122:123], v14, s[24:27], 0 offen offset:48
    v_add_u32 v31, 98304, v15
    buffer_load_ushort v124, v31, s[12:15], 0 offen
    v_add_u32 v31, 102400, v15
    buffer_load_ushort v125, v31, s[12:15], 0 offen
    v_add_u32 v31, 106496, v15
    buffer_load_ushort v126, v31, s[12:15], 0 offen
    v_add_u32 v31, 110592, v15
    buffer_load_ushort v127, v31, s[12:15], 0 offen
    s_lshl_b32 s42, s40, 10
    s_add_u32 s42, s42, 0
    s_mov_b32 m0, s42
    s_mov_b32 s43, 8257536
    buffer_load_dwordx4 v5, s[12:15], s43 offen lds
    s_lshl_b32 s42, s40, 10
    s_add_u32 s42, s42, 8192
    s_mov_b32 m0, s42
    s_mov_b32 s43, 10092544
    buffer_load_dwordx4 v6, s[12:15], s43 offen lds
    s_lshl_b32 s42, s40, 10
    s_add_u32 s42, s42, 16384
    s_mov_b32 m0, s42
    s_mov_b32 s43, 8257664
    buffer_load_dwordx4 v5, s[12:15], s43 offen lds
    s_lshl_b32 s42, s40, 10
    s_add_u32 s42, s42, 24576
    s_mov_b32 m0, s42
    s_mov_b32 s43, 10092672
    buffer_load_dwordx4 v6, s[12:15], s43 offen lds
    s_lshl_b32 s42, s40, 10
    s_add_u32 s42, s42, 32768
    s_mov_b32 m0, s42
    s_mov_b32 s43, 8257792
    buffer_load_dwordx4 v5, s[12:15], s43 offen lds
    s_lshl_b32 s42, s40, 10
    s_add_u32 s42, s42, 40960
    s_mov_b32 m0, s42
    s_mov_b32 s43, 10092800
    buffer_load_dwordx4 v6, s[12:15], s43 offen lds
    s_lshl_b32 s42, s40, 10
    s_add_u32 s42, s42, 49152
    s_mov_b32 m0, s42
    s_mov_b32 s43, 8257920
    buffer_load_dwordx4 v5, s[12:15], s43 offen lds
    s_lshl_b32 s42, s40, 10
    s_add_u32 s42, s42, 57344
    s_mov_b32 m0, s42
    s_mov_b32 s43, 10092928
    buffer_load_dwordx4 v6, s[12:15], s43 offen lds
    s_lshl_b32 s42, s40, 10
    s_add_u32 s42, s42, 65536
    s_mov_b32 m0, s42
    s_mov_b32 s43, 8258048
    buffer_load_dwordx4 v5, s[12:15], s43 offen lds
    s_lshl_b32 s42, s40, 10
    s_add_u32 s42, s42, 73728
    s_mov_b32 m0, s42
    s_mov_b32 s43, 10093056
    buffer_load_dwordx4 v6, s[12:15], s43 offen lds
    s_lshl_b32 s42, s40, 10
    s_add_u32 s42, s42, 81920
    s_mov_b32 m0, s42
    s_mov_b32 s43, 8258176
    buffer_load_dwordx4 v5, s[12:15], s43 offen lds
    s_lshl_b32 s42, s40, 10
    s_add_u32 s42, s42, 90112
    s_mov_b32 m0, s42
    s_mov_b32 s43, 10093184
    buffer_load_dwordx4 v6, s[12:15], s43 offen lds
    s_lshl_b32 s42, s40, 10
    s_add_u32 s42, s42, 98304
    s_mov_b32 m0, s42
    s_mov_b32 s43, 8258304
    buffer_load_dwordx4 v5, s[12:15], s43 offen lds
    s_lshl_b32 s42, s40, 10
    s_add_u32 s42, s42, 106496
    s_mov_b32 m0, s42
    s_mov_b32 s43, 10093312
    buffer_load_dwordx4 v6, s[12:15], s43 offen lds
    s_lshl_b32 s42, s40, 10
    s_add_u32 s42, s42, 114688
    s_mov_b32 m0, s42
    s_mov_b32 s43, 8258432
    buffer_load_dwordx4 v5, s[12:15], s43 offen lds
    s_lshl_b32 s42, s40, 10
    s_add_u32 s42, s42, 122880
    s_mov_b32 m0, s42
    s_mov_b32 s43, 10093440
    buffer_load_dwordx4 v6, s[12:15], s43 offen lds
    s_waitcnt vmcnt(14)
    s_barrier
    s_lshl_b32 s42, s40, 10
    s_add_u32 s42, s42, 131072
    s_mov_b32 m0, s42
    s_mov_b32 s43, 8258560
    buffer_load_dwordx4 v5, s[12:15], s43 offen lds
    s_lshl_b32 s42, s40, 10
    s_add_u32 s42, s42, 139264
    s_mov_b32 m0, s42
    s_mov_b32 s43, 10093568
    buffer_load_dwordx4 v6, s[12:15], s43 offen lds
    v_add_u32 v24, 0, v16
    v_add_u32 v25, 0, v17
    v_add_u32 v26, 0, v18
    v_add_u32 v27, 0, v19
    v_add_u32 v28, 0, v20
    v_add_u32 v29, 0, v21
    v_add_u32 v30, 0, v22
    v_add_u32 v31, 0, v23
    s_cmp_eq_u32 s46, 1
    s_cbranch_scc1 kh_12
    ds_read_b128 v[32:35], v24 offset:0
    ds_read_b128 v[48:51], v28 offset:0
    ds_read_b128 v[40:43], v25 offset:0
    ds_read_b128 v[56:59], v29 offset:0
    s_branch kh_13
kh_12:
    ds_read_b128 v[32:35], v26 offset:0
    ds_read_b128 v[48:51], v30 offset:0
    ds_read_b128 v[40:43], v27 offset:0
    ds_read_b128 v[56:59], v31 offset:0
kh_13:
    s_waitcnt lgkmcnt(2)
    v_mfma_f32_32x32x16_bf16 v[64:79], v[32:35], v[48:51], v[64:79]
    s_waitcnt lgkmcnt(0)
    v_mfma_f32_32x32x16_bf16 v[64:79], v[40:43], v[56:59], v[64:79]
    s_waitcnt vmcnt(14)
    s_barrier
    s_lshl_b32 s42, s40, 10
    s_add_u32 s42, s42, 0
    s_mov_b32 m0, s42
    s_mov_b32 s43, 8258688
    buffer_load_dwordx4 v5, s[12:15], s43 offen lds
    s_lshl_b32 s42, s40, 10
    s_add_u32 s42, s42, 8192
    s_mov_b32 m0, s42
    s_mov_b32 s43, 10093696
    buffer_load_dwordx4 v6, s[12:15], s43 offen lds
    v_add_u32 v24, 16384, v16
    v_add_u32 v25, 16384, v17
    v_add_u32 v26, 16384, v18
    v_add_u32 v27, 16384, v19
    v_add_u32 v28, 16384, v20
    v_add_u32 v29, 16384, v21
    v_add_u32 v30, 16384, v22
    v_add_u32 v31, 16384, v23
    s_cmp_eq_u32 s46, 1
    s_cbranch_scc1 kh_14
    ds_read_b128 v[32:35], v24 offset:0
    ds_read_b128 v[48:51], v28 offset:0
    ds_read_b128 v[40:43], v25 offset:0
    ds_read_b128 v[56:59], v29 offset:0
    s_branch kh_15
kh_14:
    ds_read_b128 v[32:35], v26 offset:0
    ds_read_b128 v[48:51], v30 offset:0
    ds_read_b128 v[40:43], v27 offset:0
    ds_read_b128 v[56:59], v31 offset:0
kh_15:
    s_waitcnt lgkmcnt(2)
    v_mfma_f32_32x32x16_bf16 v[64:79], v[32:35], v[48:51], v[64:79]
    s_waitcnt lgkmcnt(0)
    v_mfma_f32_32x32x16_bf16 v[64:79], v[40:43], v[56:59], v[64:79]
    s_waitcnt vmcnt(14)
    s_barrier
    s_lshl_b32 s42, s40, 10
    s_add_u32 s42, s42, 16384
    s_mov_b32 m0, s42
    s_mov_b32 s43, 8258816
    buffer_load_dwordx4 v5, s[12:15], s43 offen lds
    s_lshl_b32 s42, s40, 10
    s_add_u32 s42, s42, 24576
    s_mov_b32 m0, s42
    s_mov_b32 s43, 10093824
    buffer_load_dwordx4 v6, s[12:15], s43 offen lds
    v_add_u32 v24, 32768, v16
    v_add_u32 v25, 32768, v17
    v_add_u32 v26, 32768, v18
    v_add_u32 v27, 32768, v19
    v_add_u32 v28, 32768, v20
    v_add_u32 v29, 32768, v21
    v_add_u32 v30, 32768, v22
    v_add_u32 v31, 32768, v23
    s_cmp_eq_u32 s46, 1
    s_cbranch_scc1 kh_16
    ds_read_b128 v[32:35], v24 offset:0
    ds_read_b128 v[48:51], v28 offset:0
    ds_read_b128 v[40:43], v25 offset:0
    ds_read_b128 v[56:59], v29 offset:0
    s_branch kh_17
kh_16:
    ds_read_b128 v[32:35], v26 offset:0
    ds_read_b128 v[48:51], v30 offset:0
    ds_read_b128 v[40:43], v27 offset:0
    ds_read_b128 v[56:59], v31 offset:0
kh_17:
    s_waitcnt lgkmcnt(2)
    v_mfma_f32_32x32x16_bf16 v[64:79], v[32:35], v[48:51], v[64:79]
    s_waitcnt lgkmcnt(0)
    v_mfma_f32_32x32x16_bf16 v[64:79], v[40:43], v[56:59], v[64:79]
    s_waitcnt vmcnt(14)
    s_barrier
    s_lshl_b32 s42, s40, 10
    s_add_u32 s42, s42, 32768
    s_mov_b32 m0, s42
    s_mov_b32 s43, 8258944
    buffer_load_dwordx4 v5, s[12:15], s43 offen lds
    s_lshl_b32 s42, s40, 10
    s_add_u32 s42, s42, 40960
    s_mov_b32 m0, s42
    s_mov_b32 s43, 10093952
    buffer_load_dwordx4 v6, s[12:15], s43 offen lds
    v_add_u32 v24, 49152, v16
    v_add_u32 v25, 49152, v17
    v_add_u32 v26, 49152, v18
    v_add_u32 v27, 49152, v19
    v_add_u32 v28, 49152, v20
    v_add_u32 v29, 49152, v21
    v_add_u32 v30, 49152, v22
    v_add_u32 v31, 49152, v23
    s_cmp_eq_u32 s46, 1
    s_cbranch_scc1 kh_18
    ds_read_b128 v[32:35], v24 offset:0
    ds_read_b128 v[48:51], v28 offset:0
    ds_read_b128 v[40:43], v25 offset:0
    ds_read_b128 v[56:59], v29 offset:0
    s_branch kh_19
kh_18:
    ds_read_b128 v[32:35], v26 offset:0
    ds_read_b128 v[48:51], v30 offset:0
    ds_read_b128 v[40:43], v27 offset:0
    ds_read_b128 v[56:59], v31 offset:0
kh_19:
    s_waitcnt lgkmcnt(2)
    v_mfma_f32_32x32x16_bf16 v[64:79], v[32:35], v[48:51], v[64:79]
    s_waitcnt lgkmcnt(0)
    v_mfma_f32_32x32x16_bf16 v[64:79], v[40:43], v[56:59], v[64:79]
    s_waitcnt vmcnt(14)
    s_barrier
    s_lshl_b32 s42, s40, 10
    s_add_u32 s42, s42, 49152
    s_mov_b32 m0, s42
    s_mov_b32 s43, 8259072
    buffer_load_dwordx4 v5, s[12:15], s43 offen lds
    s_lshl_b32 s42, s40, 10
    s_add_u32 s42, s42, 57344
    s_mov_b32 m0, s42
    s_mov_b32 s43, 10094080
    buffer_load_dwordx4 v6, s[12:15], s43 offen lds
    v_add_u32 v24, 65536, v16
    v_add_u32 v25, 65536, v17
    v_add_u32 v26, 65536, v18
    v_add_u32 v27, 65536, v19
    v_add_u32 v28, 65536, v20
    v_add_u32 v29, 65536, v21
    v_add_u32 v30, 65536, v22
    v_add_u32 v31, 65536, v23
    s_cmp_eq_u32 s46, 1
    s_cbranch_scc1 kh_20
    ds_read_b128 v[32:35], v24 offset:0
    ds_read_b128 v[48:51], v28 offset:0
    ds_read_b128 v[40:43], v25 offset:0
    ds_read_b128 v[56:59], v29 offset:0
    s_branch kh_21
kh_20:
    ds_read_b128 v[32:35], v26 offset:0
    ds_read_b128 v[48:51], v30 offset:0
    ds_read_b128 v[40:43], v27 offset:0
    ds_read_b128 v[56:59], v31 offset:0
kh_21:
    s_waitcnt lgkmcnt(2)
    v_mfma_f32_32x32x16_bf16 v[64:79], v[32:35], v[48:51], v[64:79]
    s_waitcnt lgkmcnt(0)
    v_mfma_f32_32x32x16_bf16 v[64:79], v[40:43], v[56:59], v[64:79]
    s_waitcnt vmcnt(14)
    s_barrier
    s_lshl_b32 s42, s40, 10
    s_add_u32 s42, s42, 65536
    s_mov_b32 m0, s42
    s_mov_b32 s43, 8259200
    buffer_load_dwordx4 v5, s[12:15], s43 offen lds
    s_lshl_b32 s42, s40, 10
    s_add_u32 s42, s42, 73728
    s_mov_b32 m0, s42
    s_mov_b32 s43, 10094208
    buffer_load_dwordx4 v6, s[12:15], s43 offen lds
    v_add_u32 v24, 81920, v16
    v_add_u32 v25, 81920, v17
    v_add_u32 v26, 81920, v18
    v_add_u32 v27, 81920, v19
    v_add_u32 v28, 81920, v20
    v_add_u32 v29, 81920, v21
    v_add_u32 v30, 81920, v22
    v_add_u32 v31, 81920, v23
    s_cmp_eq_u32 s46, 1
    s_cbranch_scc1 kh_22
    ds_read_b128 v[32:35], v24 offset:0
    ds_read_b128 v[48:51], v28 offset:0
    ds_read_b128 v[40:43], v25 offset:0
    ds_read_b128 v[56:59], v29 offset:0
    s_branch kh_23
kh_22:
    ds_read_b128 v[32:35], v26 offset:0
    ds_read_b128 v[48:51], v30 offset:0
    ds_read_b128 v[40:43], v27 offset:0
    ds_read_b128 v[56:59], v31 offset:0
kh_23:
    s_waitcnt lgkmcnt(2)
    v_mfma_f32_32x32x16_bf16 v[64:79], v[32:35], v[48:51], v[64:79]
    s_waitcnt lgkmcnt(0)
    v_mfma_f32_32x32x16_bf16 v[64:79], v[40:43], v[56:59], v[64:79]
    s_waitcnt vmcnt(14)
    s_barrier
    s_lshl_b32 s42, s40, 10
    s_add_u32 s42, s42, 81920
    s_mov_b32 m0, s42
    s_mov_b32 s43, 8259328
    buffer_load_dwordx4 v5, s[12:15], s43 offen lds
    s_lshl_b32 s42, s40, 10
    s_add_u32 s42, s42, 90112
    s_mov_b32 m0, s42
    s_mov_b32 s43, 10094336
    buffer_load_dwordx4 v6, s[12:15], s43 offen lds
    v_add_u32 v24, 98304, v16
    v_add_u32 v25, 98304, v17
    v_add_u32 v26, 98304, v18
    v_add_u32 v27, 98304, v19
    v_add_u32 v28, 98304, v20
    v_add_u32 v29, 98304, v21
    v_add_u32 v30, 98304, v22
    v_add_u32 v31, 98304, v23
    s_cmp_eq_u32 s46, 1
    s_cbranch_scc1 kh_24
    ds_read_b128 v[32:35], v24 offset:0
    ds_read_b128 v[48:51], v28 offset:0
    ds_read_b128 v[40:43], v25 offset:0
    ds_read_b128 v[56:59], v29 offset:0
    s_branch kh_25
kh_24:
    ds_read_b128 v[32:35], v26 offset:0
    ds_read_b128 v[48:51], v30 offset:0
    ds_read_b128 v[40:43], v27 offset:0
    ds_read_b128 v[56:59], v31 offset:0
kh_25:
    s_waitcnt lgkmcnt(2)
    v_mfma_f32_32x32x16_bf16 v[64:79], v[32:35], v[48:51], v[64:79]
    s_waitcnt lgkmcnt(0)
    v_mfma_f32_32x32x16_bf16 v[64:79], v[40:43], v[56:59], v[64:79]
    s_waitcnt vmcnt(14)
    s_barrier
    s_lshl_b32 s42, s40, 10
    s_add_u32 s42, s42, 98304
    s_mov_b32 m0, s42
    s_mov_b32 s43, 8259456
    buffer_load_dwordx4 v5, s[12:15], s43 offen lds
    s_lshl_b32 s42, s40, 10
    s_add_u32 s42, s42, 106496
    s_mov_b32 m0, s42
    s_mov_b32 s43, 10094464
    buffer_load_dwordx4 v6, s[12:15], s43 offen lds
    v_add_u32 v24, 114688, v16
    v_add_u32 v25, 114688, v17
    v_add_u32 v26, 114688, v18
    v_add_u32 v27, 114688, v19
    v_add_u32 v28, 114688, v20
    v_add_u32 v29, 114688, v21
    v_add_u32 v30, 114688, v22
    v_add_u32 v31, 114688, v23
    s_cmp_eq_u32 s46, 1
    s_cbranch_scc1 kh_26
    ds_read_b128 v[32:35], v24 offset:0
    ds_read_b128 v[48:51], v28 offset:0
    ds_read_b128 v[40:43], v25 offset:0
    ds_read_b128 v[56:59], v29 offset:0
    s_branch kh_27
kh_26:
    ds_read_b128 v[32:35], v26 offset:0
    ds_read_b128 v[48:51], v30 offset:0
    ds_read_b128 v[40:43], v27 offset:0
    ds_read_b128 v[56:59], v31 offset:0
kh_27:
    s_waitcnt lgkmcnt(2)
    v_mfma_f32_32x32x16_bf16 v[64:79], v[32:35], v[48:51], v[64:79]
    s_waitcnt lgkmcnt(0)
    v_mfma_f32_32x32x16_bf16 v[64:79], v[40:43], v[56:59], v[64:79]
    s_waitcnt vmcnt(14)
    s_barrier
    s_lshl_b32 s42, s40, 10
    s_add_u32 s42, s42, 114688
    s_mov_b32 m0, s42
    s_mov_b32 s43, 8259584
    buffer_load_dwordx4 v5, s[12:15], s43 offen lds
    s_lshl_b32 s42, s40, 10
    s_add_u32 s42, s42, 122880
    s_mov_b32 m0, s42
    s_mov_b32 s43, 10094592
    buffer_load_dwordx4 v6, s[12:15], s43 offen lds
    v_add_u32 v24, 131072, v16
    v_add_u32 v25, 131072, v17
    v_add_u32 v26, 131072, v18
    v_add_u32 v27, 131072, v19
    v_add_u32 v28, 131072, v20
    v_add_u32 v29, 131072, v21
    v_add_u32 v30, 131072, v22
    v_add_u32 v31, 131072, v23
    s_cmp_eq_u32 s46, 1
    s_cbranch_scc1 kh_28
    ds_read_b128 v[32:35], v24 offset:0
    ds_read_b128 v[48:51], v28 offset:0
    ds_read_b128 v[40:43], v25 offset:0
    ds_read_b128 v[56:59], v29 offset:0
    s_branch kh_29
kh_28:
    ds_read_b128 v[32:35], v26 offset:0
    ds_read_b128 v[48:51], v30 offset:0
    ds_read_b128 v[40:43], v27 offset:0
    ds_read_b128 v[56:59], v31 offset:0
kh_29:
    s_waitcnt lgkmcnt(2)
    v_mfma_f32_32x32x16_bf16 v[64:79], v[32:35], v[48:51], v[64:79]
    s_waitcnt lgkmcnt(0)
    v_mfma_f32_32x32x16_bf16 v[64:79], v[40:43], v[56:59], v[64:79]
    s_waitcnt vmcnt(14)
    s_barrier
    s_lshl_b32 s42, s40, 10
    s_add_u32 s42, s42, 131072
    s_mov_b32 m0, s42
    s_mov_b32 s43, 8259712
    buffer_load_dwordx4 v5, s[12:15], s43 offen lds
    s_lshl_b32 s42, s40, 10
    s_add_u32 s42, s42, 139264
    s_mov_b32 m0, s42
    s_mov_b32 s43, 10094720
    buffer_load_dwordx4 v6, s[12:15], s43 offen lds
    v_add_u32 v24, 0, v16
    v_add_u32 v25, 0, v17
    v_add_u32 v26, 0, v18
    v_add_u32 v27, 0, v19
    v_add_u32 v28, 0, v20
    v_add_u32 v29, 0, v21
    v_add_u32 v30, 0, v22
    v_add_u32 v31, 0, v23
    s_cmp_eq_u32 s46, 1
    s_cbranch_scc1 kh_30
    ds_read_b128 v[32:35], v24 offset:0
    ds_read_b128 v[48:51], v28 offset:0
    ds_read_b128 v[40:43], v25 offset:0
    ds_read_b128 v[56:59], v29 offset:0
    s_branch kh_31
kh_30:
    ds_read_b128 v[32:35], v26 offset:0
    ds_read_b128 v[48:51], v30 offset:0
    ds_read_b128 v[40:43], v27 offset:0
    ds_read_b128 v[56:59], v31 offset:0
kh_31:
    s_waitcnt lgkmcnt(2)
    v_mfma_f32_32x32x16_bf16 v[64:79], v[32:35], v[48:51], v[64:79]
    s_waitcnt lgkmcnt(0)
    v_mfma_f32_32x32x16_bf16 v[64:79], v[40:43], v[56:59], v[64:79]
    s_waitcnt vmcnt(14)
    s_barrier
    s_lshl_b32 s42, s40, 10
    s_add_u32 s42, s42, 0
    s_mov_b32 m0, s42
    s_mov_b32 s43, 8259840
    buffer_load_dwordx4 v5, s[12:15], s43 offen lds
    s_lshl_b32 s42, s40, 10
    s_add_u32 s42, s42, 8192
    s_mov_b32 m0, s42
    s_mov_b32 s43, 10094848
    buffer_load_dwordx4 v6, s[12:15], s43 offen lds
    v_add_u32 v24, 16384, v16
    v_add_u32 v25, 16384, v17
    v_add_u32 v26, 16384, v18
    v_add_u32 v27, 16384, v19
    v_add_u32 v28, 16384, v20
    v_add_u32 v29, 16384, v21
    v_add_u32 v30, 16384, v22
    v_add_u32 v31, 16384, v23
    s_cmp_eq_u32 s46, 1
    s_cbranch_scc1 kh_32
    ds_read_b128 v[32:35], v24 offset:0
    ds_read_b128 v[48:51], v28 offset:0
    ds_read_b128 v[40:43], v25 offset:0
    ds_read_b128 v[56:59], v29 offset:0
    s_branch kh_33
kh_32:
    ds_read_b128 v[32:35], v26 offset:0
    ds_read_b128 v[48:51], v30 offset:0
    ds_read_b128 v[40:43], v27 offset:0
    ds_read_b128 v[56:59], v31 offset:0
kh_33:
    s_waitcnt lgkmcnt(2)
    v_mfma_f32_32x32x16_bf16 v[64:79], v[32:35], v[48:51], v[64:79]
    s_waitcnt lgkmcnt(0)
    v_mfma_f32_32x32x16_bf16 v[64:79], v[40:43], v[56:59], v[64:79]
    s_waitcnt vmcnt(14)
    s_barrier
    s_lshl_b32 s42, s40, 10
    s_add_u32 s42, s42, 16384
    s_mov_b32 m0, s42
    s_mov_b32 s43, 8259968
    buffer_load_dwordx4 v5, s[12:15], s43 offen lds
    s_lshl_b32 s42, s40, 10
    s_add_u32 s42, s42, 24576
    s_mov_b32 m0, s42
    s_mov_b32 s43, 10094976
    buffer_load_dwordx4 v6, s[12:15], s43 offen lds
    v_add_u32 v24, 32768, v16
    v_add_u32 v25, 32768, v17
    v_add_u32 v26, 32768, v18
    v_add_u32 v27, 32768, v19
    v_add_u32 v28, 32768, v20
    v_add_u32 v29, 32768, v21
    v_add_u32 v30, 32768, v22
    v_add_u32 v31, 32768, v23
    s_cmp_eq_u32 s46, 1
    s_cbranch_scc1 kh_34
    ds_read_b128 v[32:35], v24 offset:0
    ds_read_b128 v[48:51], v28 offset:0
    ds_read_b128 v[40:43], v25 offset:0
    ds_read_b128 v[56:59], v29 offset:0
    s_branch kh_35
kh_34:
    ds_read_b128 v[32:35], v26 offset:0
    ds_read_b128 v[48:51], v30 offset:0
    ds_read_b128 v[40:43], v27 offset:0
    ds_read_b128 v[56:59], v31 offset:0
kh_35:
    s_waitcnt lgkmcnt(2)
    v_mfma_f32_32x32x16_bf16 v[64:79], v[32:35], v[48:51], v[64:79]
    s_waitcnt lgkmcnt(0)
    v_mfma_f32_32x32x16_bf16 v[64:79], v[40:43], v[56:59], v[64:79]
    s_waitcnt vmcnt(14)
    s_barrier
    s_lshl_b32 s42, s40, 10
    s_add_u32 s42, s42, 32768
    s_mov_b32 m0, s42
    s_mov_b32 s43, 8260096
    buffer_load_dwordx4 v5, s[12:15], s43 offen lds
    s_lshl_b32 s42, s40, 10
    s_add_u32 s42, s42, 40960
    s_mov_b32 m0, s42
    s_mov_b32 s43, 10095104
    buffer_load_dwordx4 v6, s[12:15], s43 offen lds
    v_add_u32 v24, 49152, v16
    v_add_u32 v25, 49152, v17
    v_add_u32 v26, 49152, v18
    v_add_u32 v27, 49152, v19
    v_add_u32 v28, 49152, v20
    v_add_u32 v29, 49152, v21
    v_add_u32 v30, 49152, v22
    v_add_u32 v31, 49152, v23
    s_cmp_eq_u32 s46, 1
    s_cbranch_scc1 kh_36
    ds_read_b128 v[32:35], v24 offset:0
    ds_read_b128 v[48:51], v28 offset:0
    ds_read_b128 v[40:43], v25 offset:0
    ds_read_b128 v[56:59], v29 offset:0
    s_branch kh_37
kh_36:
    ds_read_b128 v[32:35], v26 offset:0
    ds_read_b128 v[48:51], v30 offset:0
    ds_read_b128 v[40:43], v27 offset:0
    ds_read_b128 v[56:59], v31 offset:0
kh_37:
    s_waitcnt lgkmcnt(2)
    v_mfma_f32_32x32x16_bf16 v[64:79], v[32:35], v[48:51], v[64:79]
    s_waitcnt lgkmcnt(0)
    v_mfma_f32_32x32x16_bf16 v[64:79], v[40:43], v[56:59], v[64:79]
    s_waitcnt vmcnt(14)
    s_barrier
    s_lshl_b32 s42, s40, 10
    s_add_u32 s42, s42, 49152
    s_mov_b32 m0, s42
    s_mov_b32 s43, 8260224
    buffer_load_dwordx4 v5, s[12:15], s43 offen lds
    s_lshl_b32 s42, s40, 10
    s_add_u32 s42, s42, 57344
    s_mov_b32 m0, s42
    s_mov_b32 s43, 10095232
    buffer_load_dwordx4 v6, s[12:15], s43 offen lds
    v_add_u32 v24, 65536, v16
    v_add_u32 v25, 65536, v17
    v_add_u32 v26, 65536, v18
    v_add_u32 v27, 65536, v19
    v_add_u32 v28, 65536, v20
    v_add_u32 v29, 65536, v21
    v_add_u32 v30, 65536, v22
    v_add_u32 v31, 65536, v23
    s_cmp_eq_u32 s46, 1
    s_cbranch_scc1 kh_38
    ds_read_b128 v[32:35], v24 offset:0
    ds_read_b128 v[48:51], v28 offset:0
    ds_read_b128 v[40:43], v25 offset:0
    ds_read_b128 v[56:59], v29 offset:0
    s_branch kh_39
kh_38:
    ds_read_b128 v[32:35], v26 offset:0
    ds_read_b128 v[48:51], v30 offset:0
    ds_read_b128 v[40:43], v27 offset:0
    ds_read_b128 v[56:59], v31 offset:0
kh_39:
    s_waitcnt lgkmcnt(2)
    v_mfma_f32_32x32x16_bf16 v[64:79], v[32:35], v[48:51], v[64:79]
    s_waitcnt lgkmcnt(0)
    v_mfma_f32_32x32x16_bf16 v[64:79], v[40:43], v[56:59], v[64:79]
    s_waitcnt vmcnt(14)
    s_barrier
    s_lshl_b32 s42, s40, 10
    s_add_u32 s42, s42, 65536
    s_mov_b32 m0, s42
    s_mov_b32 s43, 8260352
    buffer_load_dwordx4 v5, s[12:15], s43 offen lds
    s_lshl_b32 s42, s40, 10
    s_add_u32 s42, s42, 73728
    s_mov_b32 m0, s42
    s_mov_b32 s43, 10095360
    buffer_load_dwordx4 v6, s[12:15], s43 offen lds
    v_add_u32 v24, 81920, v16
    v_add_u32 v25, 81920, v17
    v_add_u32 v26, 81920, v18
    v_add_u32 v27, 81920, v19
    v_add_u32 v28, 81920, v20
    v_add_u32 v29, 81920, v21
    v_add_u32 v30, 81920, v22
    v_add_u32 v31, 81920, v23
    s_cmp_eq_u32 s46, 1
    s_cbranch_scc1 kh_40
    ds_read_b128 v[32:35], v24 offset:0
    ds_read_b128 v[48:51], v28 offset:0
    ds_read_b128 v[40:43], v25 offset:0
    ds_read_b128 v[56:59], v29 offset:0
    s_branch kh_41
kh_40:
    ds_read_b128 v[32:35], v26 offset:0
    ds_read_b128 v[48:51], v30 offset:0
    ds_read_b128 v[40:43], v27 offset:0
    ds_read_b128 v[56:59], v31 offset:0
kh_41:
    s_waitcnt lgkmcnt(2)
    v_mfma_f32_32x32x16_bf16 v[64:79], v[32:35], v[48:51], v[64:79]
    s_waitcnt lgkmcnt(0)
    v_mfma_f32_32x32x16_bf16 v[64:79], v[40:43], v[56:59], v[64:79]
    s_waitcnt vmcnt(14)
    s_barrier
    s_lshl_b32 s42, s40, 10
    s_add_u32 s42, s42, 81920
    s_mov_b32 m0, s42
    s_mov_b32 s43, 8260480
    buffer_load_dwordx4 v5, s[12:15], s43 offen lds
    s_lshl_b32 s42, s40, 10
    s_add_u32 s42, s42, 90112
    s_mov_b32 m0, s42
    s_mov_b32 s43, 10095488
    buffer_load_dwordx4 v6, s[12:15], s43 offen lds
    v_add_u32 v24, 98304, v16
    v_add_u32 v25, 98304, v17
    v_add_u32 v26, 98304, v18
    v_add_u32 v27, 98304, v19
    v_add_u32 v28, 98304, v20
    v_add_u32 v29, 98304, v21
    v_add_u32 v30, 98304, v22
    v_add_u32 v31, 98304, v23
    s_cmp_eq_u32 s46, 1
    s_cbranch_scc1 kh_42
    ds_read_b128 v[32:35], v24 offset:0
    ds_read_b128 v[48:51], v28 offset:0
    ds_read_b128 v[40:43], v25 offset:0
    ds_read_b128 v[56:59], v29 offset:0
    s_branch kh_43
kh_42:
    ds_read_b128 v[32:35], v26 offset:0
    ds_read_b128 v[48:51], v30 offset:0
    ds_read_b128 v[40:43], v27 offset:0
    ds_read_b128 v[56:59], v31 offset:0
kh_43:
    s_waitcnt lgkmcnt(2)
    v_mfma_f32_32x32x16_bf16 v[64:79], v[32:35], v[48:51], v[64:79]
    s_waitcnt lgkmcnt(0)
    v_mfma_f32_32x32x16_bf16 v[64:79], v[40:43], v[56:59], v[64:79]
    s_waitcnt vmcnt(14)
    s_barrier
    s_lshl_b32 s42, s40, 10
    s_add_u32 s42, s42, 98304
    s_mov_b32 m0, s42
    s_mov_b32 s43, 8260608
    buffer_load_dwordx4 v5, s[12:15], s43 offen lds
    s_lshl_b32 s42, s40, 10
    s_add_u32 s42, s42, 106496
    s_mov_b32 m0, s42
    s_mov_b32 s43, 10095616
    buffer_load_dwordx4 v6, s[12:15], s43 offen lds
    v_add_u32 v24, 114688, v16
    v_add_u32 v25, 114688, v17
    v_add_u32 v26, 114688, v18
    v_add_u32 v27, 114688, v19
    v_add_u32 v28, 114688, v20
    v_add_u32 v29, 114688, v21
    v_add_u32 v30, 114688, v22
    v_add_u32 v31, 114688, v23
    s_cmp_eq_u32 s46, 1
    s_cbranch_scc1 kh_44
    ds_read_b128 v[32:35], v24 offset:0
    ds_read_b128 v[48:51], v28 offset:0
    ds_read_b128 v[40:43], v25 offset:0
    ds_read_b128 v[56:59], v29 offset:0
    s_branch kh_45
kh_44:
    ds_read_b128 v[32:35], v26 offset:0
    ds_read_b128 v[48:51], v30 offset:0
    ds_read_b128 v[40:43], v27 offset:0
    ds_read_b128 v[56:59], v31 offset:0
kh_45:
    s_waitcnt lgkmcnt(2)
    v_mfma_f32_32x32x16_bf16 v[64:79], v[32:35], v[48:51], v[64:79]
    s_waitcnt lgkmcnt(0)
    v_mfma_f32_32x32x16_bf16 v[64:79], v[40:43], v[56:59], v[64:79]
    s_waitcnt vmcnt(14)
    s_barrier
    s_lshl_b32 s42, s40, 10
    s_add_u32 s42, s42, 114688
    s_mov_b32 m0, s42
    s_mov_b32 s43, 8260736
    buffer_load_dwordx4 v5, s[12:15], s43 offen lds
    s_lshl_b32 s42, s40, 10
    s_add_u32 s42, s42, 122880
    s_mov_b32 m0, s42
    s_mov_b32 s43, 10095744
    buffer_load_dwordx4 v6, s[12:15], s43 offen lds
    v_add_u32 v24, 131072, v16
    v_add_u32 v25, 131072, v17
    v_add_u32 v26, 131072, v18
    v_add_u32 v27, 131072, v19
    v_add_u32 v28, 131072, v20
    v_add_u32 v29, 131072, v21
    v_add_u32 v30, 131072, v22
    v_add_u32 v31, 131072, v23
    s_cmp_eq_u32 s46, 1
    s_cbranch_scc1 kh_46
    ds_read_b128 v[32:35], v24 offset:0
    ds_read_b128 v[48:51], v28 offset:0
    ds_read_b128 v[40:43], v25 offset:0
    ds_read_b128 v[56:59], v29 offset:0
    s_branch kh_47
kh_46:
    ds_read_b128 v[32:35], v26 offset:0
    ds_read_b128 v[48:51], v30 offset:0
    ds_read_b128 v[40:43], v27 offset:0
    ds_read_b128 v[56:59], v31 offset:0
kh_47:
    s_waitcnt lgkmcnt(2)
    v_mfma_f32_32x32x16_bf16 v[64:79], v[32:35], v[48:51], v[64:79]
    s_waitcnt lgkmcnt(0)
    v_mfma_f32_32x32x16_bf16 v[64:79], v[40:43], v[56:59], v[64:79]
    s_waitcnt vmcnt(14)
    s_barrier
    s_lshl_b32 s42, s40, 10
    s_add_u32 s42, s42, 131072
    s_mov_b32 m0, s42
    s_mov_b32 s43, 8260864
    buffer_load_dwordx4 v5, s[12:15], s43 offen lds
    s_lshl_b32 s42, s40, 10
    s_add_u32 s42, s42, 139264
    s_mov_b32 m0, s42
    s_mov_b32 s43, 10095872
    buffer_load_dwordx4 v6, s[12:15], s43 offen lds
    v_add_u32 v24, 0, v16
    v_add_u32 v25, 0, v17
    v_add_u32 v26, 0, v18
    v_add_u32 v27, 0, v19
    v_add_u32 v28, 0, v20
    v_add_u32 v29, 0, v21
    v_add_u32 v30, 0, v22
    v_add_u32 v31, 0, v23
    s_cmp_eq_u32 s46, 1
    s_cbranch_scc1 kh_48
    ds_read_b128 v[32:35], v24 offset:0
    ds_read_b128 v[48:51], v28 offset:0
    ds_read_b128 v[40:43], v25 offset:0
    ds_read_b128 v[56:59], v29 offset:0
    s_branch kh_49
kh_48:
    ds_read_b128 v[32:35], v26 offset:0
    ds_read_b128 v[48:51], v30 offset:0
    ds_read_b128 v[40:43], v27 offset:0
    ds_read_b128 v[56:59], v31 offset:0
kh_49:
    s_waitcnt lgkmcnt(2)
    v_mfma_f32_32x32x16_bf16 v[64:79], v[32:35], v[48:51], v[64:79]
    s_waitcnt lgkmcnt(0)
    v_mfma_f32_32x32x16_bf16 v[64:79], v[40:43], v[56:59], v[64:79]
    s_waitcnt vmcnt(14)
    s_barrier
    s_lshl_b32 s42, s40, 10
    s_add_u32 s42, s42, 0
    s_mov_b32 m0, s42
    s_mov_b32 s43, 8260992
    buffer_load_dwordx4 v5, s[12:15], s43 offen lds
    s_lshl_b32 s42, s40, 10
    s_add_u32 s42, s42, 8192
    s_mov_b32 m0, s42
    s_mov_b32 s43, 10096000
    buffer_load_dwordx4 v6, s[12:15], s43 offen lds
    v_add_u32 v24, 16384, v16
    v_add_u32 v25, 16384, v17
    v_add_u32 v26, 16384, v18
    v_add_u32 v27, 16384, v19
    v_add_u32 v28, 16384, v20
    v_add_u32 v29, 16384, v21
    v_add_u32 v30, 16384, v22
    v_add_u32 v31, 16384, v23
    s_cmp_eq_u32 s46, 1
    s_cbranch_scc1 kh_50
    ds_read_b128 v[32:35], v24 offset:0
    ds_read_b128 v[48:51], v28 offset:0
    ds_read_b128 v[40:43], v25 offset:0
    ds_read_b128 v[56:59], v29 offset:0
    s_branch kh_51
kh_50:
    ds_read_b128 v[32:35], v26 offset:0
    ds_read_b128 v[48:51], v30 offset:0
    ds_read_b128 v[40:43], v27 offset:0
    ds_read_b128 v[56:59], v31 offset:0
kh_51:
    s_waitcnt lgkmcnt(2)
    v_mfma_f32_32x32x16_bf16 v[64:79], v[32:35], v[48:51], v[64:79]
    s_waitcnt lgkmcnt(0)
    v_mfma_f32_32x32x16_bf16 v[64:79], v[40:43], v[56:59], v[64:79]
    s_waitcnt vmcnt(14)
    s_barrier
    v_add_u32 v24, 32768, v16
    v_add_u32 v25, 32768, v17
    v_add_u32 v26, 32768, v18
    v_add_u32 v27, 32768, v19
    v_add_u32 v28, 32768, v20
    v_add_u32 v29, 32768, v21
    v_add_u32 v30, 32768, v22
    v_add_u32 v31, 32768, v23
    s_cmp_eq_u32 s46, 1
    s_cbranch_scc1 kh_52
    ds_read_b128 v[32:35], v24 offset:0
    ds_read_b128 v[48:51], v28 offset:0
    ds_read_b128 v[40:43], v25 offset:0
    ds_read_b128 v[56:59], v29 offset:0
    s_branch kh_53
kh_52:
    ds_read_b128 v[32:35], v26 offset:0
    ds_read_b128 v[48:51], v30 offset:0
    ds_read_b128 v[40:43], v27 offset:0
    ds_read_b128 v[56:59], v31 offset:0
kh_53:
    s_waitcnt lgkmcnt(2)
    v_mfma_f32_32x32x16_bf16 v[64:79], v[32:35], v[48:51], v[64:79]
    s_waitcnt lgkmcnt(0)
    v_mfma_f32_32x32x16_bf16 v[64:79], v[40:43], v[56:59], v[64:79]
    s_waitcnt vmcnt(12)
    s_barrier
    v_add_u32 v24, 49152, v16
    v_add_u32 v25, 49152, v17
    v_add_u32 v26, 49152, v18
    v_add_u32 v27, 49152, v19
    v_add_u32 v28, 49152, v20
    v_add_u32 v29, 49152, v21
    v_add_u32 v30, 49152, v22
    v_add_u32 v31, 49152, v23
    s_cmp_eq_u32 s46, 1
    s_cbranch_scc1 kh_54
    ds_read_b128 v[32:35], v24 offset:0
    ds_read_b128 v[48:51], v28 offset:0
    ds_read_b128 v[40:43], v25 offset:0
    ds_read_b128 v[56:59], v29 offset:0
    s_branch kh_55
kh_54:
    ds_read_b128 v[32:35], v26 offset:0
    ds_read_b128 v[48:51], v30 offset:0
    ds_read_b128 v[40:43], v27 offset:0
    ds_read_b128 v[56:59], v31 offset:0
kh_55:
    s_waitcnt lgkmcnt(2)
    v_mfma_f32_32x32x16_bf16 v[64:79], v[32:35], v[48:51], v[64:79]
    s_waitcnt lgkmcnt(0)
    v_mfma_f32_32x32x16_bf16 v[64:79], v[40:43], v[56:59], v[64:79]
    s_waitcnt vmcnt(10)
    s_barrier
    v_add_u32 v24, 65536, v16
    v_add_u32 v25, 65536, v17
    v_add_u32 v26, 65536, v18
    v_add_u32 v27, 65536, v19
    v_add_u32 v28, 65536, v20
    v_add_u32 v29, 65536, v21
    v_add_u32 v30, 65536, v22
    v_add_u32 v31, 65536, v23
    s_cmp_eq_u32 s46, 1
    s_cbranch_scc1 kh_56
    ds_read_b128 v[32:35], v24 offset:0
    ds_read_b128 v[48:51], v28 offset:0
    ds_read_b128 v[40:43], v25 offset:0
    ds_read_b128 v[56:59], v29 offset:0
    s_branch kh_57
kh_56:
    ds_read_b128 v[32:35], v26 offset:0
    ds_read_b128 v[48:51], v30 offset:0
    ds_read_b128 v[40:43], v27 offset:0
    ds_read_b128 v[56:59], v31 offset:0
kh_57:
    s_waitcnt lgkmcnt(2)
    v_mfma_f32_32x32x16_bf16 v[64:79], v[32:35], v[48:51], v[64:79]
    s_waitcnt lgkmcnt(0)
    v_mfma_f32_32x32x16_bf16 v[64:79], v[40:43], v[56:59], v[64:79]
    s_waitcnt vmcnt(8)
    s_barrier
    v_add_u32 v24, 81920, v16
    v_add_u32 v25, 81920, v17
    v_add_u32 v26, 81920, v18
    v_add_u32 v27, 81920, v19
    v_add_u32 v28, 81920, v20
    v_add_u32 v29, 81920, v21
    v_add_u32 v30, 81920, v22
    v_add_u32 v31, 81920, v23
    s_cmp_eq_u32 s46, 1
    s_cbranch_scc1 kh_58
    ds_read_b128 v[32:35], v24 offset:0
    ds_read_b128 v[48:51], v28 offset:0
    ds_read_b128 v[40:43], v25 offset:0
    ds_read_b128 v[56:59], v29 offset:0
    s_branch kh_59
kh_58:
    ds_read_b128 v[32:35], v26 offset:0
    ds_read_b128 v[48:51], v30 offset:0
    ds_read_b128 v[40:43], v27 offset:0
    ds_read_b128 v[56:59], v31 offset:0
kh_59:
    s_waitcnt lgkmcnt(2)
    v_mfma_f32_32x32x16_bf16 v[64:79], v[32:35], v[48:51], v[64:79]
    s_waitcnt lgkmcnt(0)
    v_mfma_f32_32x32x16_bf16 v[64:79], v[40:43], v[56:59], v[64:79]
    s_waitcnt vmcnt(6)
    s_barrier
    v_add_u32 v24, 98304, v16
    v_add_u32 v25, 98304, v17
    v_add_u32 v26, 98304, v18
    v_add_u32 v27, 98304, v19
    v_add_u32 v28, 98304, v20
    v_add_u32 v29, 98304, v21
    v_add_u32 v30, 98304, v22
    v_add_u32 v31, 98304, v23
    s_cmp_eq_u32 s46, 1
    s_cbranch_scc1 kh_60
    ds_read_b128 v[32:35], v24 offset:0
    ds_read_b128 v[48:51], v28 offset:0
    ds_read_b128 v[40:43], v25 offset:0
    ds_read_b128 v[56:59], v29 offset:0
    s_branch kh_61
kh_60:
    ds_read_b128 v[32:35], v26 offset:0
    ds_read_b128 v[48:51], v30 offset:0
    ds_read_b128 v[40:43], v27 offset:0
    ds_read_b128 v[56:59], v31 offset:0
kh_61:
    s_waitcnt lgkmcnt(2)
    v_mfma_f32_32x32x16_bf16 v[64:79], v[32:35], v[48:51], v[64:79]
    s_waitcnt lgkmcnt(0)
    v_mfma_f32_32x32x16_bf16 v[64:79], v[40:43], v[56:59], v[64:79]
    s_waitcnt vmcnt(4)
    s_barrier
    v_add_u32 v24, 114688, v16
    v_add_u32 v25, 114688, v17
    v_add_u32 v26, 114688, v18
    v_add_u32 v27, 114688, v19
    v_add_u32 v28, 114688, v20
    v_add_u32 v29, 114688, v21
    v_add_u32 v30, 114688, v22
    v_add_u32 v31, 114688, v23
    s_cmp_eq_u32 s46, 1
    s_cbranch_scc1 kh_62
    ds_read_b128 v[32:35], v24 offset:0
    ds_read_b128 v[48:51], v28 offset:0
    ds_read_b128 v[40:43], v25 offset:0
    ds_read_b128 v[56:59], v29 offset:0
    s_branch kh_63
kh_62:
    ds_read_b128 v[32:35], v26 offset:0
    ds_read_b128 v[48:51], v30 offset:0
    ds_read_b128 v[40:43], v27 offset:0
    ds_read_b128 v[56:59], v31 offset:0
kh_63:
    s_waitcnt lgkmcnt(2)
    v_mfma_f32_32x32x16_bf16 v[64:79], v[32:35], v[48:51], v[64:79]
    s_waitcnt lgkmcnt(0)
    v_mfma_f32_32x32x16_bf16 v[64:79], v[40:43], v[56:59], v[64:79]
    s_waitcnt vmcnt(2)
    s_barrier
    v_add_u32 v24, 131072, v16
    v_add_u32 v25, 131072, v17
    v_add_u32 v26, 131072, v18
    v_add_u32 v27, 131072, v19
    v_add_u32 v28, 131072, v20
    v_add_u32 v29, 131072, v21
    v_add_u32 v30, 131072, v22
    v_add_u32 v31, 131072, v23
    s_cmp_eq_u32 s46, 1
    s_cbranch_scc1 kh_64
    ds_read_b128 v[32:35], v24 offset:0
    ds_read_b128 v[48:51], v28 offset:0
    ds_read_b128 v[40:43], v25 offset:0
    ds_read_b128 v[56:59], v29 offset:0
    s_branch kh_65
kh_64:
    ds_read_b128 v[32:35], v26 offset:0
    ds_read_b128 v[48:51], v30 offset:0
    ds_read_b128 v[40:43], v27 offset:0
    ds_read_b128 v[56:59], v31 offset:0
kh_65:
    s_waitcnt lgkmcnt(2)
    v_mfma_f32_32x32x16_bf16 v[64:79], v[32:35], v[48:51], v[64:79]
    s_waitcnt lgkmcnt(0)
    v_mfma_f32_32x32x16_bf16 v[64:79], v[40:43], v[56:59], v[64:79]
    s_waitcnt vmcnt(0)
    s_barrier
    v_add_u32 v24, 0, v16
    v_add_u32 v25, 0, v17
    v_add_u32 v26, 0, v18
    v_add_u32 v27, 0, v19
    v_add_u32 v28, 0, v20
    v_add_u32 v29, 0, v21
    v_add_u32 v30, 0, v22
    v_add_u32 v31, 0, v23
    s_cmp_eq_u32 s46, 1
    s_cbranch_scc1 kh_66
    ds_read_b128 v[32:35], v24 offset:0
    ds_read_b128 v[48:51], v28 offset:0
    ds_read_b128 v[40:43], v25 offset:0
    ds_read_b128 v[56:59], v29 offset:0
    s_branch kh_67
kh_66:
    ds_read_b128 v[32:35], v26 offset:0
    ds_read_b128 v[48:51], v30 offset:0
    ds_read_b128 v[40:43], v27 offset:0
    ds_read_b128 v[56:59], v31 offset:0
kh_67:
    s_waitcnt lgkmcnt(2)
    v_mfma_f32_32x32x16_bf16 v[64:79], v[32:35], v[48:51], v[64:79]
    s_waitcnt lgkmcnt(0)
    v_mfma_f32_32x32x16_bf16 v[64:79], v[40:43], v[56:59], v[64:79]
    s_nop 7
    s_nop 7
    s_barrier
    v_and_b32 v12, 3, v1
    v_lshlrev_b32 v12, 12, v12
    v_lshl_add_u32 v12, v2, 4, v12
    s_cmp_eq_u32 s46, 0
    s_cbranch_scc1 gred_69
    ds_write_b128 v12, v[64:67] offset:0
    ds_write_b128 v12, v[68:71] offset:1024
    ds_write_b128 v12, v[72:75] offset:2048
    ds_write_b128 v12, v[76:79] offset:3072
    s_waitcnt lgkmcnt(0)
    s_barrier
    s_waitcnt vmcnt(0)
    s_endpgm
gred_69:
    s_barrier
    ds_read_b128 v[32:35], v12 offset:0
    ds_read_b128 v[36:39], v12 offset:1024
    ds_read_b128 v[40:43], v12 offset:2048
    ds_read_b128 v[44:47], v12 offset:3072
    s_waitcnt lgkmcnt(0)
    v_add_f32 v64, v64, v32
    v_add_f32 v65, v65, v33
    v_add_f32 v66, v66, v34
    v_add_f32 v67, v67, v35
    v_add_f32 v68, v68, v36
    v_add_f32 v69, v69, v37
    v_add_f32 v70, v70, v38
    v_add_f32 v71, v71, v39
    v_add_f32 v72, v72, v40
    v_add_f32 v73, v73, v41
    v_add_f32 v74, v74, v42
    v_add_f32 v75, v75, v43
    v_add_f32 v76, v76, v44
    v_add_f32 v77, v77, v45
    v_add_f32 v78, v78, v46
    v_add_f32 v79, v79, v47
    v_cvt_pk_bf16_f32 v64, v64, v64
    v_lshlrev_b32 v64, 16, v64
    v_lshlrev_b32 v38, 16, v96
    v_add_f32 v64, v64, v38
    v_cvt_pk_bf16_f32 v64, v64, v64
    v_lshlrev_b32 v64, 16, v64
    v_lshlrev_b32 v38, 16, v98
    v_lshlrev_b32 v39, 16, v100
    v_add_f32 v38, v38, v39
    v_cvt_pk_bf16_f32 v38, v38, v38
    v_lshlrev_b32 v38, 16, v38
    v_add_f32 v64, v64, v38
    v_cvt_pk_bf16_f32 v65, v65, v65
    v_lshlrev_b32 v65, 16, v65
    v_and_b32 v38, 0xffff0000, v96
    v_add_f32 v65, v65, v38
    v_cvt_pk_bf16_f32 v65, v65, v65
    v_lshlrev_b32 v65, 16, v65
    v_and_b32 v38, 0xffff0000, v98
    v_lshlrev_b32 v39, 16, v101
    v_add_f32 v38, v38, v39
    v_cvt_pk_bf16_f32 v38, v38, v38
    v_lshlrev_b32 v38, 16, v38
    v_add_f32 v65, v65, v38
    v_cvt_pk_bf16_f32 v66, v66, v66
    v_lshlrev_b32 v66, 16, v66
    v_lshlrev_b32 v38, 16, v97
    v_add_f32 v66, v66, v38
    v_cvt_pk_bf16_f32 v66, v66, v66
    v_lshlrev_b32 v66, 16, v66
    v_lshlrev_b32 v38, 16, v99
    v_lshlrev_b32 v39, 16, v102
    v_add_f32 v38, v38, v39
    v_cvt_pk_bf16_f32 v38, v38, v38
    v_lshlrev_b32 v38, 16, v38
    v_add_f32 v66, v66, v38
    v_cvt_pk_bf16_f32 v67, v67, v67
    v_lshlrev_b32 v67, 16, v67
    v_and_b32 v38, 0xffff0000, v97
    v_add_f32 v67, v67, v38
    v_cvt_pk_bf16_f32 v67, v67, v67
    v_lshlrev_b32 v67, 16, v67
    v_and_b32 v38, 0xffff0000, v99
    v_lshlrev_b32 v39, 16, v103
    v_add_f32 v38, v38, v39
    v_cvt_pk_bf16_f32 v38, v38, v38
    v_lshlrev_b32 v38, 16, v38
    v_add_f32 v67, v67, v38
    v_cvt_pk_bf16_f32 v32, v64, v65
    v_cvt_pk_bf16_f32 v33, v66, v67
    buffer_store_dwordx2 v[32:33], v14, s[28:31], 0 offen offset:0
    v_cvt_pk_bf16_f32 v68, v68, v68
    v_lshlrev_b32 v68, 16, v68
    v_lshlrev_b32 v38, 16, v104
    v_add_f32 v68, v68, v38
    v_cvt_pk_bf16_f32 v68, v68, v68
    v_lshlrev_b32 v68, 16, v68
    v_lshlrev_b32 v38, 16, v106
    v_lshlrev_b32 v39, 16, v108
    v_add_f32 v38, v38, v39
    v_cvt_pk_bf16_f32 v38, v38, v38
    v_lshlrev_b32 v38, 16, v38
    v_add_f32 v68, v68, v38
    v_cvt_pk_bf16_f32 v69, v69, v69
    v_lshlrev_b32 v69, 16, v69
    v_and_b32 v38, 0xffff0000, v104
    v_add_f32 v69, v69, v38
    v_cvt_pk_bf16_f32 v69, v69, v69
    v_lshlrev_b32 v69, 16, v69
    v_and_b32 v38, 0xffff0000, v106
    v_lshlrev_b32 v39, 16, v109
    v_add_f32 v38, v38, v39
    v_cvt_pk_bf16_f32 v38, v38, v38
    v_lshlrev_b32 v38, 16, v38
    v_add_f32 v69, v69, v38
    v_cvt_pk_bf16_f32 v70, v70, v70
    v_lshlrev_b32 v70, 16, v70
    v_lshlrev_b32 v38, 16, v105
    v_add_f32 v70, v70, v38
    v_cvt_pk_bf16_f32 v70, v70, v70
    v_lshlrev_b32 v70, 16, v70
    v_lshlrev_b32 v38, 16, v107
    v_lshlrev_b32 v39, 16, v110
    v_add_f32 v38, v38, v39
    v_cvt_pk_bf16_f32 v38, v38, v38
    v_lshlrev_b32 v38, 16, v38
    v_add_f32 v70, v70, v38
    v_cvt_pk_bf16_f32 v71, v71, v71
    v_lshlrev_b32 v71, 16, v71
    v_and_b32 v38, 0xffff0000, v105
    v_add_f32 v71, v71, v38
    v_cvt_pk_bf16_f32 v71, v71, v71
    v_lshlrev_b32 v71, 16, v71
    v_and_b32 v38, 0xffff0000, v107
    v_lshlrev_b32 v39, 16, v111
    v_add_f32 v38, v38, v39
    v_cvt_pk_bf16_f32 v38, v38, v38
    v_lshlrev_b32 v38, 16, v38
    v_add_f32 v71, v71, v38
    v_cvt_pk_bf16_f32 v34, v68, v69
    v_cvt_pk_bf16_f32 v35, v70, v71
    buffer_store_dwordx2 v[34:35], v14, s[28:31], 0 offen offset:16
    v_cvt_pk_bf16_f32 v72, v72, v72
    v_lshlrev_b32 v72, 16, v72
    v_lshlrev_b32 v38, 16, v112
    v_add_f32 v72, v72, v38
    v_cvt_pk_bf16_f32 v72, v72, v72
    v_lshlrev_b32 v72, 16, v72
    v_lshlrev_b32 v38, 16, v114
    v_lshlrev_b32 v39, 16, v116
    v_add_f32 v38, v38, v39
    v_cvt_pk_bf16_f32 v38, v38, v38
    v_lshlrev_b32 v38, 16, v38
    v_add_f32 v72, v72, v38
    v_cvt_pk_bf16_f32 v73, v73, v73
    v_lshlrev_b32 v73, 16, v73
    v_and_b32 v38, 0xffff0000, v112
    v_add_f32 v73, v73, v38
    v_cvt_pk_bf16_f32 v73, v73, v73
    v_lshlrev_b32 v73, 16, v73
    v_and_b32 v38, 0xffff0000, v114
    v_lshlrev_b32 v39, 16, v117
    v_add_f32 v38, v38, v39
    v_cvt_pk_bf16_f32 v38, v38, v38
    v_lshlrev_b32 v38, 16, v38
    v_add_f32 v73, v73, v38
    v_cvt_pk_bf16_f32 v74, v74, v74
    v_lshlrev_b32 v74, 16, v74
    v_lshlrev_b32 v38, 16, v113
    v_add_f32 v74, v74, v38
    v_cvt_pk_bf16_f32 v74, v74, v74
    v_lshlrev_b32 v74, 16, v74
    v_lshlrev_b32 v38, 16, v115
    v_lshlrev_b32 v39, 16, v118
    v_add_f32 v38, v38, v39
    v_cvt_pk_bf16_f32 v38, v38, v38
    v_lshlrev_b32 v38, 16, v38
    v_add_f32 v74, v74, v38
    v_cvt_pk_bf16_f32 v75, v75, v75
    v_lshlrev_b32 v75, 16, v75
    v_and_b32 v38, 0xffff0000, v113
    v_add_f32 v75, v75, v38
    v_cvt_pk_bf16_f32 v75, v75, v75
    v_lshlrev_b32 v75, 16, v75
    v_and_b32 v38, 0xffff0000, v115
    v_lshlrev_b32 v39, 16, v119
    v_add_f32 v38, v38, v39
    v_cvt_pk_bf16_f32 v38, v38, v38
    v_lshlrev_b32 v38, 16, v38
    v_add_f32 v75, v75, v38
    v_cvt_pk_bf16_f32 v36, v72, v73
    v_cvt_pk_bf16_f32 v37, v74, v75
    buffer_store_dwordx2 v[36:37], v14, s[28:31], 0 offen offset:32
    v_cvt_pk_bf16_f32 v76, v76, v76
    v_lshlrev_b32 v76, 16, v76
    v_lshlrev_b32 v38, 16, v120
    v_add_f32 v76, v76, v38
    v_cvt_pk_bf16_f32 v76, v76, v76
    v_lshlrev_b32 v76, 16, v76
    v_lshlrev_b32 v38, 16, v122
    v_lshlrev_b32 v39, 16, v124
    v_add_f32 v38, v38, v39
    v_cvt_pk_bf16_f32 v38, v38, v38
    v_lshlrev_b32 v38, 16, v38
    v_add_f32 v76, v76, v38
    v_cvt_pk_bf16_f32 v77, v77, v77
    v_lshlrev_b32 v77, 16, v77
    v_and_b32 v38, 0xffff0000, v120
    v_add_f32 v77, v77, v38
    v_cvt_pk_bf16_f32 v77, v77, v77
    v_lshlrev_b32 v77, 16, v77
    v_and_b32 v38, 0xffff0000, v122
    v_lshlrev_b32 v39, 16, v125
    v_add_f32 v38, v38, v39
    v_cvt_pk_bf16_f32 v38, v38, v38
    v_lshlrev_b32 v38, 16, v38
    v_add_f32 v77, v77, v38
    v_cvt_pk_bf16_f32 v78, v78, v78
    v_lshlrev_b32 v78, 16, v78
    v_lshlrev_b32 v38, 16, v121
    v_add_f32 v78, v78, v38
    v_cvt_pk_bf16_f32 v78, v78, v78
    v_lshlrev_b32 v78, 16, v78
    v_lshlrev_b32 v38, 16, v123
    v_lshlrev_b32 v39, 16, v126
    v_add_f32 v38, v38, v39
    v_cvt_pk_bf16_f32 v38, v38, v38
    v_lshlrev_b32 v38, 16, v38
    v_add_f32 v78, v78, v38
    v_cvt_pk_bf16_f32 v79, v79, v79
    v_lshlrev_b32 v79, 16, v79
    v_and_b32 v38, 0xffff0000, v121
    v_add_f32 v79, v79, v38
    v_cvt_pk_bf16_f32 v79, v79, v79
    v_lshlrev_b32 v79, 16, v79
    v_and_b32 v38, 0xffff0000, v123
    v_lshlrev_b32 v39, 16, v127
    v_add_f32 v38, v38, v39
    v_cvt_pk_bf16_f32 v38, v38, v38
    v_lshlrev_b32 v38, 16, v38
    v_add_f32 v79, v79, v38
    v_cvt_pk_bf16_f32 v38, v76, v77
    v_cvt_pk_bf16_f32 v39, v78, v79
    buffer_store_dwordx2 v[38:39], v14, s[28:31], 0 offen offset:48
    s_waitcnt vmcnt(0)
end_11:
    s_endpgm
.section .rodata,"a"
.p2align 6
.amdhsa_kernel k1_kernel
  .amdhsa_next_free_vgpr 96
  .amdhsa_next_free_sgpr 102
  .amdhsa_accum_offset 96
  .amdhsa_group_segment_fixed_size 0
  .amdhsa_kernarg_size 136
  .amdhsa_user_sgpr_count 2
  .amdhsa_user_sgpr_kernarg_segment_ptr 1
  .amdhsa_system_sgpr_workgroup_id_x 1
.end_amdhsa_kernel
.p2align 6
.amdhsa_kernel k2_kernel
  .amdhsa_next_free_vgpr 144
  .amdhsa_next_free_sgpr 102
  .amdhsa_accum_offset 144
  .amdhsa_group_segment_fixed_size 0
  .amdhsa_kernarg_size 136
  .amdhsa_user_sgpr_count 2
  .amdhsa_user_sgpr_kernarg_segment_ptr 1
  .amdhsa_system_sgpr_workgroup_id_x 1
.end_amdhsa_kernel
.p2align 6
.amdhsa_kernel k3_kernel
  .amdhsa_next_free_vgpr 128
  .amdhsa_next_free_sgpr 102
  .amdhsa_accum_offset 128
  .amdhsa_group_segment_fixed_size 0
  .amdhsa_kernarg_size 136
  .amdhsa_user_sgpr_count 2
  .amdhsa_user_sgpr_kernarg_segment_ptr 1
  .amdhsa_system_sgpr_workgroup_id_x 1
.end_amdhsa_kernel
```
